```python
import torch

def _softmax(x, axis=-1):
    return torch.softmax(x, dim=axis)
def _gelu(x):
    return torch.nn.functional.gelu(x, approximate="tanh")
def _silu(x):
    return torch.nn.functional.silu(x)
def _sigmoid(x):
    return torch.sigmoid(x)
def _layernorm(x, axis=-1, eps=1e-5):
    m = x.mean(dim=axis, keepdim=True)
    v = x.var(dim=axis, keepdim=True, unbiased=False)
    return (x - m) / torch.sqrt(v + eps)
def _scatter_add(tgt, idx, src, axis=0):
    return tgt.clone().index_add_(axis, idx, src)
def _segment_sum(src, seg, n):
    out = torch.zeros((n,) + src.shape[1:], dtype=src.dtype)
    return out.index_add_(0, seg, src)
def _pad(x, pw):
    flat = tuple(v for pair in reversed(pw) for v in pair)
    return torch.nn.functional.pad(x, flat)

kernel_name = 'gated_mix__sliding_local_dilated__spectral_fnet__prompt'

def setup_inputs():

    _w = (lambda a: (lambda t: t.to(torch.bfloat16) if t.is_floating_point() else t)(torch.as_tensor(a)))
    def _A_setup():
        B, S, D = 1, 2048, 640
        return {
            "x": _w((lambda *s: torch.randn(*s, dtype=torch.bfloat16) * 0.05)(B, S, D)),
            "wqkv": _w((lambda *s: torch.randn(*s, dtype=torch.bfloat16) * 1.6)(D, 3 * D)),
            "wo": _w((lambda *s: torch.randn(*s, dtype=torch.bfloat16) * 0.2)(D, D)),
        }
    _A_in = _A_setup()

    def _B_setup():
        B, S, D = 1, 2048, 640
        ns = torch.arange(S)[:, None] * torch.arange(S)[None, :]
        nd = torch.arange(D)[:, None] * torch.arange(D)[None, :]
        Ws_re = torch.cos(-2.0 * torch.pi * ns / S).to(float)
        Ws_im = torch.sin(-2.0 * torch.pi * ns / S).to(float)
        Wd_re = torch.cos(-2.0 * torch.pi * nd / D).to(float)
        Wd_im = torch.sin(-2.0 * torch.pi * nd / D).to(float)
        return {
            "x": _w((lambda *s: torch.randn(*s, dtype=torch.bfloat16) * 0.05)(B, S, D)),
            "dft_seq_re": _w(Ws_re),
            "dft_seq_im": _w(Ws_im),
            "dft_hid_re": _w(Wd_re),
            "dft_hid_im": _w(Wd_im),
        }
    _B_in = _B_setup()

    return {
        "A_x": _A_in["x"],
        "A_wqkv": _A_in["wqkv"],
        "A_wo": _A_in["wo"],
        "B_x": _B_in["x"],
        "B_dft_seq_re": _B_in["dft_seq_re"],
        "B_dft_seq_im": _B_in["dft_seq_im"],
        "B_dft_hid_re": _B_in["dft_hid_re"],
        "B_dft_hid_im": _B_in["dft_hid_im"],
        "gate_w": _w((lambda *s: torch.randn(*s, dtype=torch.bfloat16) * 0.05)(640) * 16.0),
    }

def reference(A_x, A_wqkv, A_wo, B_x, B_dft_seq_re, B_dft_seq_im, B_dft_hid_re, B_dft_hid_im, gate_w):
    def _A_ref(x, wqkv, wo):
        B, S, D = x.shape
        H = 32; Dh = D // H
        W, dil = 8, 2
        qkv = (lambda x, *d: x.permute(*d))((x @ wqkv).reshape(B, S, 3, H, Dh), 2, 0, 3, 1, 4)
        q, k, v = qkv[0], qkv[1], qkv[2]
        scale = Dh ** -0.5
        pos = torch.arange(S)
        off = torch.arange(W) * dil
        idx = pos[:, None] - off[None, :]
        mask = idx >= 0
        idx_c = torch.where(mask, idx, 0).reshape(-1)
        kg = k[:, :, idx_c, :].reshape(B, H, S, W, Dh)
        vg = v[:, :, idx_c, :].reshape(B, H, S, W, Dh)
        logits = torch.einsum("bhsd,bhswd->bhsw", q, kg) * scale
        logits = torch.where(mask[None, None, :, :], logits, -1e9)
        attn = _softmax(logits, axis=-1)
        o = torch.einsum("bhsw,bhswd->bhsd", attn, vg)
        return (lambda x, *d: x.permute(*d))(o, 0, 2, 1, 3).reshape(B, S, D) @ wo

    def _B_ref(x, dft_seq_re, dft_seq_im, dft_hid_re, dft_hid_im):
        a = torch.einsum("bsd,ed->bse", x, dft_hid_re)
        b = torch.einsum("bsd,ed->bse", x, dft_hid_im)
        y = torch.einsum("ts,bse->bte", dft_seq_re, a) - torch.einsum("ts,bse->bte", dft_seq_im, b)
        return y

    x = A_x
    g = _sigmoid((x * gate_w).sum(-1, keepdims=True))
    a = _A_ref(x, A_wqkv, A_wo)
    b = _B_ref(x, B_dft_seq_re, B_dft_seq_im, B_dft_hid_re, B_dft_hid_im)
    return g * a + (1 - g) * b
```

```asm
; @launch grid=(256,1,1) block=(512,1,1) lds=163840
.amdgcn_target "amdgcn-amd-amdhsa--gfx950"
.text
.globl gated_mix__sliding_local_dilated__spectral_fnet__prompt_kernel
.p2align 8
.type gated_mix__sliding_local_dilated__spectral_fnet__prompt_kernel,@function
gated_mix__sliding_local_dilated__spectral_fnet__prompt_kernel:
s_load_dwordx2 s[4:5], s[0:1], 0
s_load_dwordx2 s[8:9], s[0:1], 8
v_lshrrev_b32 v1, 6, v0
s_lshr_b32 s22, s2, 3
s_cbranch_scc1 L_npf
s_getpc_b64 s[28:29]
v_lshlrev_b32 v2, 7, v0
v_min_u32 v2, 0xb800, v2
global_load_dword v39, v2, s[28:29]
L_npf:
v_readfirstlane_b32 s20, v1
s_cmp_ge_u32 s22, 32
s_cbranch_scc1 L_end
v_and_b32 v0, 63, v0
s_and_b32 s21, s2, 7
s_cmp_eq_u32 s20, 1
s_cbranch_scc1 L_fx
s_cmp_lg_u32 s20, 0
s_cbranch_scc1 L_fd
v_lshrrev_b32 v3, 3, v0
v_and_b32 v4, 7, v0
v_min_u32 v4, 4, v4
v_mad_u32_u24 v3, v3, 10, v4
s_lshr_b32 s28, s21, 2
s_lshl4_add_u32 s27, s22, s28
s_mul_i32 s27, s27, 5
v_add_lshl_u32 v3, v3, s27, 7
s_waitcnt lgkmcnt(0)
global_load_dword v39, v3, s[8:9]
s_branch L_fd
L_fx:
s_and_b32 s27, s22, 15
s_cmp_ge_u32 s27, 9
s_cbranch_scc1 L_fd
s_lshl_b32 s27, s27, 6
s_and_b32 s28, s21, 2
s_mulk_i32 s28, 525
s_and_b32 s29, s21, 1
s_add_u32 s28, s28, s29
s_lshl1_add_u32 s27, s27, s28
v_lshl_add_u32 v3, v0, 1, s27
v_min_u32 v3, 0x7ff, v3
s_lshr_b32 s28, s22, 4
v_mad_u32_u24 v3, v3, 10, s28
v_lshlrev_b32 v3, 7, v3
s_waitcnt lgkmcnt(0)
global_load_dword v39, v3, s[4:5]
L_fd:
s_load_dwordx2 s[12:13], s[0:1], 88
s_load_dwordx2 s[16:17], s[0:1], 64
s_lshl3_add_u32 s27, s2, s20
s_cmpk_lg_u32 s27, 71
s_cbranch_scc1 L_ntg
s_load_dwordx2 s[28:29], s[0:1], 80
s_memrealtime s[34:35]
v_mov_b32 v3, 0
s_mov_b64 exec, 1
s_waitcnt lgkmcnt(0)
s_or_b32 s34, s34, 1
v_mov_b32 v4, s34
v_mov_b32 v5, s35
global_store_dwordx2 v3, v[4:5], s[28:29] sc1
s_mov_b64 exec, -1
L_ntg:
s_mov_b32 s6, 2621440
s_mov_b32 s7, 0x20000
s_mov_b32 s10, 2457600
s_mov_b32 s11, 0x20000
s_mov_b32 s14, 8388608
s_mov_b32 s15, 0x20000
s_mov_b32 s19, 0x20000
s_mov_b32 s43, 0x20000
s_cmp_lt_u32 s22, 12
s_cbranch_scc1 L_na
s_sub_u32 s27, s22, 12
s_lshr_b32 s28, s27, 2
s_and_b32 s24, s21, 1
s_bfe_u32 s29, s21, 0x10001
s_mul_i32 s29, s29, 5
s_add_u32 s23, s29, s28
s_mul_i32 s26, s23, 105
s_and_b32 s27, s27, 3
s_and_b32 s29, s21, 4
s_add_u32 s25, s29, s27
s_cmp_lt_u32 s20, 4
s_cbranch_scc1 L_ac
s_cmp_lg_u32 s20, 7
s_cbranch_scc1 L_a_wl
v_lshrrev_b32 v2, 3, v0
v_and_b32 v3, 7, v0
v_lshrrev_b32 v4, 4, v0
v_xor_b32 v3, v3, v4
v_mul_u32_u24 v2, 2560, v2
v_lshl_add_u32 v20, v3, 4, v2
v_xor_b32 v21, 64, v20
s_lshl_b32 s36, s26, 1
s_add_u32 s36, s36, s24
s_mul_i32 s36, s36, 1280
s_mov_b32 m0, 40960
s_mov_b32 s37, s36
s_movk_i32 s27, 7
s_waitcnt lgkmcnt(0)
L_a_x0:
buffer_load_dwordx4 v20, s[4:7], s37 offen lds
s_add_u32 m0, m0, 1024
s_add_u32 s37, s37, 20480
buffer_load_dwordx4 v21, s[4:7], s37 offen lds
s_add_u32 m0, m0, 1024
s_add_u32 s37, s37, 20480
s_sub_u32 s27, s27, 1
s_cmp_lg_u32 s27, 0
s_cbranch_scc1 L_a_x0
s_branch L_a_xl
L_a_wl:
s_sub_u32 s27, s20, 4
s_mul_i32 s28, s27, 320
v_add_u32 v3, s28, v0
s_mul_i32 s36, s25, 160
s_mul_i32 s37, s27, 5120
s_add_u32 s37, s37, 83968
s_movk_i32 s28, 2185
s_movk_i32 s29, 6554
s_movk_i32 s30, 1120
s_movk_i32 s31, 15360
s_add_u32 m0, s37, 0
v_mul_u32_u24 v4, s28, v3
v_mul_u32_u24 v5, s29, v3
v_lshrrev_b32 v5, 16, v5
v_mul_u32_u24 v5, s30, v5
v_lshl_add_u32 v5, v3, 4, v5
v_bfe_u32 v6, v4, 18, 1
v_bfe_u32 v4, v4, 19, 1
v_sub_u32 v4, v6, v4
v_mad_i32_i24 v20, s31, v4, v5
v_add_u32 v3, 64, v3
s_waitcnt lgkmcnt(0)
buffer_load_dwordx4 v20, s[8:11], s36 offen lds
s_add_u32 m0, m0, 1024
v_mul_u32_u24 v4, s28, v3
v_mul_u32_u24 v5, s29, v3
v_lshrrev_b32 v5, 16, v5
v_mul_u32_u24 v5, s30, v5
v_lshl_add_u32 v5, v3, 4, v5
v_bfe_u32 v6, v4, 18, 1
v_bfe_u32 v4, v4, 19, 1
v_sub_u32 v4, v6, v4
v_mad_i32_i24 v21, s31, v4, v5
v_add_u32 v3, 64, v3
buffer_load_dwordx4 v21, s[8:11], s36 offen lds
s_add_u32 m0, m0, 1024
v_mul_u32_u24 v4, s28, v3
v_mul_u32_u24 v5, s29, v3
v_lshrrev_b32 v5, 16, v5
v_mul_u32_u24 v5, s30, v5
v_lshl_add_u32 v5, v3, 4, v5
v_bfe_u32 v6, v4, 18, 1
v_bfe_u32 v4, v4, 19, 1
v_sub_u32 v4, v6, v4
v_mad_i32_i24 v22, s31, v4, v5
v_add_u32 v3, 64, v3
buffer_load_dwordx4 v22, s[8:11], s36 offen lds
s_add_u32 m0, m0, 1024
v_mul_u32_u24 v4, s28, v3
v_mul_u32_u24 v5, s29, v3
v_lshrrev_b32 v5, 16, v5
v_mul_u32_u24 v5, s30, v5
v_lshl_add_u32 v5, v3, 4, v5
v_bfe_u32 v6, v4, 18, 1
v_bfe_u32 v4, v4, 19, 1
v_sub_u32 v4, v6, v4
v_mad_i32_i24 v23, s31, v4, v5
v_add_u32 v3, 64, v3
buffer_load_dwordx4 v23, s[8:11], s36 offen lds
s_add_u32 m0, m0, 1024
v_mul_u32_u24 v4, s28, v3
v_mul_u32_u24 v5, s29, v3
v_lshrrev_b32 v5, 16, v5
v_mul_u32_u24 v5, s30, v5
v_lshl_add_u32 v5, v3, 4, v5
v_bfe_u32 v6, v4, 18, 1
v_bfe_u32 v4, v4, 19, 1
v_sub_u32 v4, v6, v4
v_mad_i32_i24 v24, s31, v4, v5
buffer_load_dwordx4 v24, s[8:11], s36 offen lds
s_add_u32 s36, s36, 122880
s_branch L_a_w2
L_ac:
s_cmp_eq_u32 s25, 0
s_cselect_b32 s18, 1280, 0
s_lshl_b32 s27, s20, 7
v_lshl_add_u32 v242, v0, 1, s27
s_waitcnt lgkmcnt(0)
buffer_load_ushort v248, v242, s[16:19], 0 offen offset:0
buffer_load_ushort v250, v242, s[16:19], 0 offen offset:512
buffer_load_ushort v252, v242, s[16:19], 0 offen offset:1024
s_branch L_a_comp
L_na:
s_cmp_ge_u32 s20, 6
s_cbranch_scc1 L_tn
s_lshl_b32 s27, s20, 2
s_add_u32 s27, s27, s22
s_mov_b32 s46, 3
s_mov_b32 s47, 3
s_cmp_lt_u32 s22, 4
s_cbranch_scc1 L_tt
s_cmp_ge_u32 s20, 3
s_cselect_b32 s27, 3, 0
s_cselect_b32 s47, 1, 1
s_cselect_b32 s46, 2, 1
s_sub_u32 s27, s20, s27
s_lshl_b32 s27, s27, 3
s_add_u32 s27, s27, s22
s_sub_u32 s27, s27, 4
L_tt:
s_lshl_b32 s28, s27, 6
v_add_u32 v3, s28, v0
s_cmp_ge_u32 s27, 15
s_cbranch_scc1 L_ts_xe
v_mul_u32_u24 v4, 13108, v3
v_lshrrev_b32 v4, 16, v4
v_mul_u32_u24 v4, 640, v4
v_lshl_add_u32 v12, v3, 7, v4
s_lshr_b32 s44, s21, 2
s_mul_i32 s44, s44, 640
s_mov_b32 s45, 245760
s_mov_b32 s42, 2457600
s_waitcnt lgkmcnt(0)
s_mov_b32 s40, s8
s_mov_b32 s41, s9
s_branch L_ts_de
L_ts_xe:
v_subrev_u32 v3, 960, v3
v_mul_u32_u24 v12, 2560, v3
s_bfe_u32 s28, s21, 0x10001
s_mul_i32 s28, s28, 1050
s_and_b32 s29, s21, 1
s_add_u32 s28, s28, s29
s_mul_i32 s44, s28, 1280
s_movk_i32 s45, 128
s_mov_b32 s42, 2621440
s_waitcnt lgkmcnt(0)
s_mov_b32 s40, s4
s_mov_b32 s41, s5
L_ts_de:
s_mul_i32 s46, s46, s45
s_add_u32 s46, s46, s44
L_tl:
s_sub_u32 s47, s47, 1
s_cbranch_scc1 L_td
buffer_load_dword v39, v12, s[40:43], s46 offen
s_add_u32 s46, s46, s45
s_branch L_tl
L_tn:
s_mov_b32 s42, 0
s_mov_b32 s44, 0
s_mov_b32 s45, 0
v_mov_b32 v12, 0
s_waitcnt lgkmcnt(0)
s_mov_b32 s40, s4
s_mov_b32 s41, s5
L_td:
s_cmp_ge_u32 s22, 4
s_cbranch_scc1 L_b1
L_h_o:
s_load_dwordx2 s[16:17], s[0:1], 80
s_load_dwordx2 s[88:89], s[0:1], 16
s_mov_b32 s18, 256
s_mov_b32 s90, 819200
s_mov_b32 s91, 0x20000
s_load_dwordx2 s[92:93], s[0:1], 72
s_and_b32 s84, s22, 7
s_lshr_b32 s86, s22, 4
s_lshl_b32 s86, s86, 3
s_add_u32 s86, s86, s21
s_sub_u32 s87, 32, s86
s_cmp_eq_u32 s86, 0
s_cselect_b32 s87, 16, s87
s_bitcmp1_b32 s22, 3
s_cselect_b32 s85, s87, s86
s_mov_b32 s94, 2621440
s_mov_b32 s95, 0x20000
v_mov_b32 v3, 0
s_cmp_ge_u32 s20, 5
s_cbranch_scc1 L_h_f
v_add_u32 v7, 0, v0
v_mul_u32_u24 v4, 6554, v7
v_lshrrev_b32 v4, 16, v4
v_mul_u32_u24 v5, 1120, v4
v_lshl_add_u32 v5, v7, 4, v5
v_bfe_u32 v6, v4, 2, 1
v_bfe_u32 v4, v4, 3, 1
v_sub_u32 v4, v6, v4
v_mul_i32_i24 v4, 5120, v4
v_add_u32 v26, v5, v4
v_add_u32 v7, 64, v0
v_mul_u32_u24 v4, 6554, v7
v_lshrrev_b32 v4, 16, v4
v_mul_u32_u24 v5, 1120, v4
v_lshl_add_u32 v5, v7, 4, v5
v_bfe_u32 v6, v4, 2, 1
v_bfe_u32 v4, v4, 3, 1
v_sub_u32 v4, v6, v4
v_mul_i32_i24 v4, 5120, v4
v_add_u32 v27, v5, v4
v_add_u32 v7, 128, v0
v_mul_u32_u24 v4, 6554, v7
v_lshrrev_b32 v4, 16, v4
v_mul_u32_u24 v5, 1120, v4
v_lshl_add_u32 v5, v7, 4, v5
v_bfe_u32 v6, v4, 2, 1
v_bfe_u32 v4, v4, 3, 1
v_sub_u32 v4, v6, v4
v_mul_i32_i24 v4, 5120, v4
v_add_u32 v28, v5, v4
v_add_u32 v7, 192, v0
v_mul_u32_u24 v4, 6554, v7
v_lshrrev_b32 v4, 16, v4
v_mul_u32_u24 v5, 1120, v4
v_lshl_add_u32 v5, v7, 4, v5
v_bfe_u32 v6, v4, 2, 1
v_bfe_u32 v4, v4, 3, 1
v_sub_u32 v4, v6, v4
v_mul_i32_i24 v4, 5120, v4
v_add_u32 v29, v5, v4
v_add_u32 v7, 256, v0
v_mul_u32_u24 v4, 6554, v7
v_lshrrev_b32 v4, 16, v4
v_mul_u32_u24 v5, 1120, v4
v_lshl_add_u32 v5, v7, 4, v5
v_bfe_u32 v6, v4, 2, 1
v_bfe_u32 v4, v4, 3, 1
v_sub_u32 v4, v6, v4
v_mul_i32_i24 v4, 5120, v4
v_add_u32 v30, v5, v4
s_mul_i32 s27, s22, 5
s_add_u32 s27, s27, s20
s_mul_i32 s38, s27, 40960
s_mul_i32 s28, s21, 160
s_add_u32 s38, s38, s28
s_mul_i32 s39, s20, 5120
s_mov_b32 m0, s39
s_mul_i32 s28, s21, 20
s_add_u32 s28, s28, s27
s_mul_i32 s30, s28, 5120
s_add_u32 s30, s30, 7340032
s_add_u32 s31, s30, 4096
v_lshrrev_b32 v6, 5, v0
v_bfe_u32 v7, v0, 2, 3
v_lshl_add_u32 v6, v6, 4, v7
v_mul_u32_u24 v6, 160, v6
v_and_b32 v7, 3, v0
v_lshl_add_u32 v6, v7, 3, v6
v_add_u32 v6, s39, v6
v_lshlrev_b32 v5, 4, v0
s_waitcnt vmcnt(9) lgkmcnt(0)
buffer_load_dwordx4 v26, s[88:91], s38 offen lds
s_add_u32 m0, m0, 1024
s_nop 0
buffer_load_dwordx4 v27, s[88:91], s38 offen lds
s_add_u32 m0, m0, 1024
s_nop 0
buffer_load_dwordx4 v28, s[88:91], s38 offen lds
s_add_u32 m0, m0, 1024
s_nop 0
buffer_load_dwordx4 v29, s[88:91], s38 offen lds
s_add_u32 m0, m0, 1024
s_nop 0
buffer_load_dwordx4 v30, s[88:91], s38 offen lds
s_waitcnt vmcnt(0)
ds_read_b64_tr_b16 v[40:41], v6 offset:0
ds_read_b64_tr_b16 v[42:43], v6 offset:1280
ds_read_b64_tr_b16 v[44:45], v6 offset:32
ds_read_b64_tr_b16 v[46:47], v6 offset:1312
ds_read_b64_tr_b16 v[48:49], v6 offset:64
ds_read_b64_tr_b16 v[50:51], v6 offset:1344
ds_read_b64_tr_b16 v[52:53], v6 offset:96
ds_read_b64_tr_b16 v[54:55], v6 offset:1376
ds_read_b64_tr_b16 v[56:57], v6 offset:128
ds_read_b64_tr_b16 v[58:59], v6 offset:1408
s_waitcnt lgkmcnt(0)
buffer_store_dwordx4 v[40:43], v5, s[12:15], s30 offen offset:0 sc1
buffer_store_dwordx4 v[44:47], v5, s[12:15], s30 offen offset:1024 sc1
buffer_store_dwordx4 v[48:51], v5, s[12:15], s30 offen offset:2048 sc1
buffer_store_dwordx4 v[52:55], v5, s[12:15], s30 offen offset:3072 sc1
buffer_store_dwordx4 v[56:59], v5, s[12:15], s31 offen offset:0 sc1
L_h_f:
L_h_p:
s_waitcnt lgkmcnt(0)
s_cmp_lg_u32 s20, 0
s_cbranch_scc1 L_h_t0
s_load_dwordx2 s[96:97], s[16:17], 0
L_h_t0:
s_waitcnt vmcnt(0) lgkmcnt(0)
s_barrier
s_cmp_eq_u32 s20, 0
s_cbranch_scc1 L_h_t1
s_load_dwordx2 s[96:97], s[16:17], 0
L_h_t1:
s_waitcnt lgkmcnt(0)
s_cmp_lg_u32 s96, 0
s_cbranch_scc1 L_tg1
s_movk_i32 s59, 30000
v_mov_b32 v4, 0
L_th1:
s_sleep 8
buffer_load_dwordx2 v[2:3], v4, s[16:19], 0 offen sc1
s_waitcnt vmcnt(0)
v_readfirstlane_b32 s96, v2
v_readfirstlane_b32 s97, v3
s_sub_u32 s59, s59, 1
s_cbranch_scc1 L_tg1
s_cmp_eq_u32 s96, 0
s_cbranch_scc1 L_th1
s_nop 1
L_tg1:
s_cmp_lg_u32 s20, 0
s_cbranch_scc1 L_h_nf
s_lshl_b32 s27, s2, 7
s_add_u32 s27, s27, 5255168
v_lshrrev_b32 v2, 3, v0
v_lshlrev_b32 v2, 14, v2
v_and_b32 v3, 7, v0
v_lshl_add_u32 v2, v3, 4, v2
v_mov_b32 v4, s96
v_mov_b32 v5, s97
v_mov_b32 v6, s96
v_mov_b32 v7, s97
buffer_store_dwordx4 v[4:7], v2, s[12:15], s27 offen sc1
L_h_nf:
v_lshlrev_b32 v12, 4, v0
v_mov_b32 v8, 4290772927
v_mov_b32 v9, 4290772927
v_mov_b32 v10, 4290772927
v_mov_b32 v11, 4290772927
s_lshl_b32 s30, s2, 3
s_add_u32 s30, s30, s20
s_lshl_b32 s31, s30, 5
s_add_u32 s31, s31, 2621440
s_mul_i32 s30, s30, 10240
s_add_u32 s30, s30, 0
s_barrier
buffer_store_dwordx4 v[8:11], v12, s[12:15], s30 offen offset:0 sc1
buffer_store_dwordx4 v[8:11], v12, s[12:15], s30 offen offset:1024 sc1
buffer_store_dwordx4 v[8:11], v12, s[12:15], s30 offen offset:2048 sc1
buffer_store_dwordx4 v[8:11], v12, s[12:15], s30 offen offset:3072 sc1
s_add_u32 s30, s30, 4096
buffer_store_dwordx4 v[8:11], v12, s[12:15], s30 offen offset:0 sc1
buffer_store_dwordx4 v[8:11], v12, s[12:15], s30 offen offset:1024 sc1
buffer_store_dwordx4 v[8:11], v12, s[12:15], s30 offen offset:2048 sc1
buffer_store_dwordx4 v[8:11], v12, s[12:15], s30 offen offset:3072 sc1
s_add_u32 s30, s30, 4096
buffer_store_dwordx4 v[8:11], v12, s[12:15], s30 offen offset:0 sc1
buffer_store_dwordx4 v[8:11], v12, s[12:15], s30 offen offset:1024 sc1
s_cmp_lg_u32 s20, 0
s_cbranch_scc1 L_h_nz
s_mov_b64 exec, 0xffff
buffer_store_dwordx4 v[8:11], v12, s[12:15], s31 offen sc1
s_mov_b64 exec, -1
L_h_nz:
s_waitcnt vmcnt(2)
s_lshl_b32 s56, s21, 14
s_add_u32 s56, s56, 5255168
s_lshl_b32 s57, s84, 7
s_add_u32 s57, s57, s56
s_load_dwordx2 s[50:51], s[12:13], s57
s_add_u32 s57, s57, 1024
s_load_dwordx2 s[52:53], s[12:13], s57
s_add_u32 s57, s57, 1024
s_load_dwordx2 s[44:45], s[12:13], s57
s_add_u32 s57, s57, 1024
s_load_dwordx2 s[46:47], s[12:13], s57
s_lshl_b32 s27, s2, 7
s_add_u32 s27, s27, 5505024
v_lshrrev_b32 v2, 3, v0
v_lshlrev_b32 v2, 13, v2
v_and_b32 v3, 7, v0
v_lshl_add_u32 v2, v3, 4, v2
v_mov_b32 v4, s96
v_mov_b32 v5, s97
v_mov_b32 v6, s96
v_mov_b32 v7, s97
s_cmp_lg_u32 s20, 0
s_waitcnt vmcnt(0) lgkmcnt(0)
s_barrier
s_cbranch_scc1 L_2_ent
buffer_store_dwordx4 v[4:7], v2, s[12:15], s27 offen sc1
s_nop 0
s_branch L_2_ent
L_a_w2:
s_add_u32 m0, s37, 15360
s_nop 0
buffer_load_dwordx4 v20, s[8:11], s36 offen lds
s_add_u32 m0, m0, 1024
s_nop 0
buffer_load_dwordx4 v21, s[8:11], s36 offen lds
s_add_u32 m0, m0, 1024
s_nop 0
buffer_load_dwordx4 v22, s[8:11], s36 offen lds
s_add_u32 m0, m0, 1024
s_nop 0
buffer_load_dwordx4 v23, s[8:11], s36 offen lds
s_add_u32 m0, m0, 1024
s_nop 0
buffer_load_dwordx4 v24, s[8:11], s36 offen lds
s_add_u32 s36, s36, 122880
s_load_dwordx2 s[16:17], s[0:1], 80
s_mov_b32 s18, 256
s_load_dwordx2 s[92:93], s[0:1], 72
s_and_b32 s84, s22, 7
s_lshr_b32 s86, s22, 4
s_lshl_b32 s86, s86, 3
s_add_u32 s86, s86, s21
s_sub_u32 s87, 32, s86
s_cmp_eq_u32 s86, 0
s_cselect_b32 s87, 16, s87
s_bitcmp1_b32 s22, 3
s_cselect_b32 s85, s87, s86
s_mov_b32 s94, 2621440
s_mov_b32 s95, 0x20000
v_bfe_u32 v32, v0, 1, 3
v_lshrrev_b32 v33, 4, v0
s_sub_u32 s29, s20, 4
s_lshl_b32 s27, s29, 2
v_add_u32 v33, s27, v33
s_xor_b32 s28, s29, 3
s_lshl_b32 s28, s28, 3
s_add_u32 s28, s28, 149504
v_lshl_add_u32 v35, v32, 4, v33
v_mul_u32_u24 v9, 1440, v32
v_and_b32 v32, 1, v33
v_mul_u32_u24 v32, 10152, v32
v_mul_u32_u24 v33, 88, v33
v_add3_u32 v9, v9, v32, v33
v_lshl_add_u32 v12, v35, 5, s28
v_and_b32 v34, 1, v0
v_bfe_u32 v32, v0, 3, 0
v_lshl_add_u32 v9, v34, 4, v9
v_lshl_add_u32 v9, v32, 5, v9
v_add_u32 v9, 129024, v9
v_lshlrev_b32 v34, 4, v34
v_lshl_add_u32 v34, v32, 9, v34
s_cmp_eq_u32 s23, 0
s_cselect_b32 s28, 0, 7
s_sub_u32 s29, 1024, s26
s_min_u32 s29, s29, 112
s_waitcnt vmcnt(5)
s_barrier
s_add_u32 m0, s37, 30720
s_cmp_eq_u32 s25, 0
s_cselect_b32 s27, 0x55555555, 0
buffer_load_dwordx4 v20, s[8:11], s36 offen lds
s_add_u32 m0, m0, 1024
v_cmp_le_u32 vcc, s28, v35
v_cmp_gt_u32 s[30:31], s29, v35
buffer_load_dwordx4 v21, s[8:11], s36 offen lds
s_add_u32 m0, m0, 1024
v_add_u32 v33, s26, v35
s_and_b64 vcc, vcc, s[30:31]
buffer_load_dwordx4 v22, s[8:11], s36 offen lds
s_add_u32 m0, m0, 1024
v_lshl_add_u32 v33, v33, 1, s24
v_and_b32 v32, 31, v33
buffer_load_dwordx4 v23, s[8:11], s36 offen lds
s_add_u32 m0, m0, 1024
v_mul_u32_u24 v10, 81920, v32
v_lshrrev_b32 v36, 5, v33
buffer_load_dwordx4 v24, s[8:11], s36 offen lds
s_add_u32 s36, s36, 122880
s_waitcnt vmcnt(5)
s_barrier
s_add_u32 m0, s37, 46080
v_lshl_add_u32 v36, v32, 6, v36
v_lshlrev_b32 v36, 2, v36
buffer_load_dwordx4 v20, s[8:11], s36 offen lds
s_add_u32 m0, m0, 1024
v_lshrrev_b32 v32, 9, v33
v_mul_u32_u24 v32, 20480, v32
buffer_load_dwordx4 v21, s[8:11], s36 offen lds
s_add_u32 m0, m0, 1024
v_bfe_u32 v33, v33, 5, 4
v_lshl_add_u32 v32, v33, 5, v32
buffer_load_dwordx4 v22, s[8:11], s36 offen lds
s_add_u32 m0, m0, 1024
v_add3_u32 v10, v10, v32, v34
v_mov_b32 v32, 1073741824
buffer_load_dwordx4 v23, s[8:11], s36 offen lds
s_add_u32 m0, m0, 1024
v_cndmask_b32 v10, v32, v10, vcc
s_and_b32 vcc_lo, vcc_lo, s27
buffer_load_dwordx4 v24, s[8:11], s36 offen lds
s_add_u32 s36, s36, 122880
s_waitcnt vmcnt(5)
s_barrier
s_add_u32 m0, s37, 0
s_and_b32 vcc_hi, vcc_hi, s27
v_add_u32 v35, 64, v35
buffer_load_dwordx4 v20, s[8:11], s36 offen lds
s_add_u32 m0, m0, 1024
v_cndmask_b32 v36, v32, v36, vcc
s_mov_b32 s54, 2621440
buffer_load_dwordx4 v21, s[8:11], s36 offen lds
s_add_u32 m0, m0, 1024
s_lshl_b32 s27, s23, 3
s_add_u32 s27, s27, s25
buffer_load_dwordx4 v22, s[8:11], s36 offen lds
s_add_u32 m0, m0, 1024
s_add_u32 s29, s27, 0
s_and_b32 s29, s29, 3
s_cselect_b32 s29, 1073741824, 0
buffer_load_dwordx4 v23, s[8:11], s36 offen lds
s_add_u32 m0, m0, 1024
s_lshr_b32 s27, s27, 2
s_lshl_b32 s28, s24, 7
buffer_load_dwordx4 v24, s[8:11], s36 offen lds
s_add_u32 s36, s36, 122880
s_waitcnt vmcnt(5)
s_barrier
s_add_u32 m0, s37, 15360
s_add_u32 s27, s27, s28
s_lshl_b32 s27, s27, 7
buffer_load_dwordx4 v20, s[8:11], s36 offen lds
s_add_u32 m0, m0, 1024
s_add_u32 s27, s27, s29
s_add_u32 s55, s27, 5242880
buffer_load_dwordx4 v21, s[8:11], s36 offen lds
s_add_u32 m0, m0, 1024
v_lshrrev_b32 v38, 3, v0
v_lshlrev_b32 v38, 15, v38
buffer_load_dwordx4 v22, s[8:11], s36 offen lds
s_add_u32 m0, m0, 1024
v_and_b32 v33, 7, v0
v_cmp_gt_u32 vcc, 32, v0
buffer_load_dwordx4 v23, s[8:11], s36 offen lds
s_add_u32 m0, m0, 1024
v_lshl_add_u32 v38, v33, 4, v38
s_mul_i32 s53, s25, 2560
buffer_load_dwordx4 v24, s[8:11], s36 offen lds
s_add_u32 s36, s36, 122880
s_waitcnt vmcnt(5)
s_barrier
s_add_u32 m0, s37, 30720
v_cndmask_b32 v38, v32, v38, vcc
s_add_u32 s53, s53, 0
buffer_load_dwordx4 v20, s[8:11], s36 offen lds
s_add_u32 m0, m0, 1024
v_lshlrev_b32 v26, 4, v0
s_sub_u32 s27, s20, 4
buffer_load_dwordx4 v21, s[8:11], s36 offen lds
s_add_u32 m0, m0, 1024
s_mul_i32 s39, s27, 5120
s_mul_i32 s38, s84, 102400
buffer_load_dwordx4 v22, s[8:11], s36 offen lds
s_add_u32 m0, m0, 1024
s_add_u32 s38, s38, s39
s_add_u32 s38, s38, 7340032
buffer_load_dwordx4 v23, s[8:11], s36 offen lds
s_add_u32 m0, m0, 1024
v_lshlrev_b32 v76, 7, v0
s_lshl_b32 s49, s21, 13
buffer_load_dwordx4 v24, s[8:11], s36 offen lds
s_add_u32 s36, s36, 122880
s_waitcnt vmcnt(5)
s_barrier
s_add_u32 m0, s37, 46080
s_add_u32 s49, s49, 5373952
s_lshl_b32 s56, s21, 14
buffer_load_dwordx4 v20, s[8:11], s36 offen lds
s_add_u32 m0, m0, 1024
s_add_u32 s56, s56, 5255168
s_mov_b32 s48, 0
buffer_load_dwordx4 v21, s[8:11], s36 offen lds
s_add_u32 m0, m0, 1024
v_add_u32 v4, 0, v0
v_mul_u32_u24 v5, 13108, v4
buffer_load_dwordx4 v22, s[8:11], s36 offen lds
s_add_u32 m0, m0, 1024
v_lshrrev_b32 v5, 16, v5
v_mul_u32_u24 v5, 57264, v5
buffer_load_dwordx4 v23, s[8:11], s36 offen lds
s_add_u32 m0, m0, 1024
v_lshl_add_u32 v77, v4, 4, v5
v_add_u32 v4, 64, v0
buffer_load_dwordx4 v24, s[8:11], s36 offen lds
s_add_u32 s36, s36, 122880
s_waitcnt vmcnt(5)
s_barrier
s_add_u32 m0, s37, 0
v_mul_u32_u24 v5, 13108, v4
v_lshrrev_b32 v5, 16, v5
buffer_load_dwordx4 v20, s[8:11], s36 offen lds
s_add_u32 m0, m0, 1024
v_mul_u32_u24 v5, 57264, v5
v_lshl_add_u32 v78, v4, 4, v5
buffer_load_dwordx4 v21, s[8:11], s36 offen lds
s_add_u32 m0, m0, 1024
v_add_u32 v4, 128, v0
v_mul_u32_u24 v5, 13108, v4
buffer_load_dwordx4 v22, s[8:11], s36 offen lds
s_add_u32 m0, m0, 1024
v_lshrrev_b32 v5, 16, v5
v_mul_u32_u24 v5, 57264, v5
buffer_load_dwordx4 v23, s[8:11], s36 offen lds
s_add_u32 m0, m0, 1024
v_lshl_add_u32 v79, v4, 4, v5
s_sub_u32 s28, 7, s84
buffer_load_dwordx4 v24, s[8:11], s36 offen lds
s_add_u32 s36, s36, 122880
s_waitcnt vmcnt(5)
s_barrier
s_add_u32 m0, s37, 15360
s_sub_u32 s29, 32, s85
s_and_b32 s29, s29, 31
buffer_load_dwordx4 v20, s[8:11], s36 offen lds
s_add_u32 m0, m0, 1024
s_lshl_b32 s43, s29, 3
s_add_u32 s43, s43, s28
buffer_load_dwordx4 v21, s[8:11], s36 offen lds
s_add_u32 m0, m0, 1024
s_mul_i32 s43, s43, 80
s_add_u32 s43, s43, 3145728
buffer_load_dwordx4 v22, s[8:11], s36 offen lds
s_add_u32 m0, m0, 1024
s_lshl_b32 s41, s85, 3
s_add_u32 s41, s41, s84
buffer_load_dwordx4 v23, s[8:11], s36 offen lds
s_add_u32 m0, m0, 1024
s_mul_i32 s41, s41, 80
s_add_u32 s41, s41, 3145728
buffer_load_dwordx4 v24, s[8:11], s36 offen lds
s_add_u32 s36, s36, 122880
s_waitcnt vmcnt(5)
s_barrier
s_add_u32 m0, s37, 30720
s_cmp_ge_u32 s84, 4
s_cselect_b32 s28, s28, s84
s_cselect_b32 s29, s29, s85
s_cselect_b32 s40, 4, 0
buffer_load_dwordx4 v20, s[8:11], s36 offen lds
s_add_u32 m0, m0, 1024
s_lshl_b32 s29, s29, 2
s_add_u32 s28, s28, s29
buffer_load_dwordx4 v21, s[8:11], s36 offen lds
s_add_u32 m0, m0, 1024
s_mul_i32 s28, s28, 192
s_add_u32 s42, s28, 3178496
buffer_load_dwordx4 v22, s[8:11], s36 offen lds
s_add_u32 m0, m0, 1024
s_add_u32 s40, s40, s42
s_add_u32 s40, s40, 80
buffer_load_dwordx4 v23, s[8:11], s36 offen lds
s_add_u32 m0, m0, 1024
s_lshl_b32 s28, s20, 2
s_add_u32 s28, s28, 112800
buffer_load_dwordx4 v24, s[8:11], s36 offen lds
s_add_u32 s36, s36, 122880
s_waitcnt lgkmcnt(0)
s_load_dwordx2 s[96:97], s[16:17], 0
s_waitcnt vmcnt(5)
s_barrier
s_add_u32 m0, s37, 46080
v_mov_b32 v80, s28
buffer_load_dwordx4 v20, s[8:11], s36 offen lds
s_add_u32 m0, m0, 1024
s_nop 0
buffer_load_dwordx4 v21, s[8:11], s36 offen lds
s_add_u32 m0, m0, 1024
s_nop 0
buffer_load_dwordx4 v22, s[8:11], s36 offen lds
s_add_u32 m0, m0, 1024
s_nop 0
buffer_load_dwordx4 v23, s[8:11], s36 offen lds
s_add_u32 m0, m0, 1024
s_nop 0
buffer_load_dwordx4 v24, s[8:11], s36 offen lds
s_add_u32 s36, s36, 122880
s_waitcnt vmcnt(5)
s_barrier
s_add_u32 m0, s37, 0
s_nop 0
buffer_load_dwordx4 v20, s[8:11], s36 offen lds
s_add_u32 m0, m0, 1024
s_nop 0
buffer_load_dwordx4 v21, s[8:11], s36 offen lds
s_add_u32 m0, m0, 1024
s_nop 0
buffer_load_dwordx4 v22, s[8:11], s36 offen lds
s_add_u32 m0, m0, 1024
s_nop 0
buffer_load_dwordx4 v23, s[8:11], s36 offen lds
s_add_u32 m0, m0, 1024
s_nop 0
buffer_load_dwordx4 v24, s[8:11], s36 offen lds
s_add_u32 s36, s36, 122880
s_waitcnt lgkmcnt(0)
s_cmp_lg_u32 s96, 0
s_cbranch_scc1 L_tg2
s_movk_i32 s59, 30000
v_mov_b32 v86, 0
L_th2:
s_sleep 8
buffer_load_dwordx2 v[84:85], v86, s[16:19], 0 offen sc1
s_waitcnt vmcnt(0)
v_readfirstlane_b32 s96, v84
v_readfirstlane_b32 s97, v85
s_sub_u32 s59, s59, 1
s_cbranch_scc1 L_tg2
s_cmp_eq_u32 s96, 0
s_cbranch_scc1 L_th2
s_nop 1
L_tg2:
s_waitcnt vmcnt(5)
s_barrier
s_add_u32 m0, s37, 15360
s_nop 0
buffer_load_dwordx4 v20, s[8:11], s36 offen lds
s_add_u32 m0, m0, 1024
s_nop 0
buffer_load_dwordx4 v21, s[8:11], s36 offen lds
s_add_u32 m0, m0, 1024
s_nop 0
buffer_load_dwordx4 v22, s[8:11], s36 offen lds
s_add_u32 m0, m0, 1024
s_nop 0
buffer_load_dwordx4 v23, s[8:11], s36 offen lds
s_add_u32 m0, m0, 1024
s_nop 0
buffer_load_dwordx4 v24, s[8:11], s36 offen lds
s_add_u32 s36, s36, 122880
s_waitcnt vmcnt(5)
s_barrier
s_add_u32 m0, s37, 30720
s_nop 0
buffer_load_dwordx4 v20, s[8:11], s36 offen lds
s_add_u32 m0, m0, 1024
s_nop 0
buffer_load_dwordx4 v21, s[8:11], s36 offen lds
s_add_u32 m0, m0, 1024
s_nop 0
buffer_load_dwordx4 v22, s[8:11], s36 offen lds
s_add_u32 m0, m0, 1024
s_nop 0
buffer_load_dwordx4 v23, s[8:11], s36 offen lds
s_add_u32 m0, m0, 1024
s_nop 0
buffer_load_dwordx4 v24, s[8:11], s36 offen lds
s_add_u32 s36, s36, 122880
s_waitcnt vmcnt(5)
s_barrier
s_add_u32 m0, s37, 46080
s_nop 0
buffer_load_dwordx4 v20, s[8:11], s36 offen lds
s_add_u32 m0, m0, 1024
s_nop 0
buffer_load_dwordx4 v21, s[8:11], s36 offen lds
s_add_u32 m0, m0, 1024
s_nop 0
buffer_load_dwordx4 v22, s[8:11], s36 offen lds
s_add_u32 m0, m0, 1024
s_nop 0
buffer_load_dwordx4 v23, s[8:11], s36 offen lds
s_add_u32 m0, m0, 1024
s_nop 0
buffer_load_dwordx4 v24, s[8:11], s36 offen lds
s_add_u32 s36, s36, 122880
s_waitcnt vmcnt(5)
s_barrier
s_add_u32 m0, s37, 0
s_nop 0
buffer_load_dwordx4 v20, s[8:11], s36 offen lds
s_add_u32 m0, m0, 1024
s_nop 0
buffer_load_dwordx4 v21, s[8:11], s36 offen lds
s_add_u32 m0, m0, 1024
s_nop 0
buffer_load_dwordx4 v22, s[8:11], s36 offen lds
s_add_u32 m0, m0, 1024
s_nop 0
buffer_load_dwordx4 v23, s[8:11], s36 offen lds
s_add_u32 m0, m0, 1024
s_nop 0
buffer_load_dwordx4 v24, s[8:11], s36 offen lds
s_add_u32 s36, s36, 122880
s_waitcnt vmcnt(5)
s_barrier
s_add_u32 m0, s37, 15360
s_nop 0
buffer_load_dwordx4 v20, s[8:11], s36 offen lds
s_add_u32 m0, m0, 1024
s_nop 0
buffer_load_dwordx4 v21, s[8:11], s36 offen lds
s_add_u32 m0, m0, 1024
s_nop 0
buffer_load_dwordx4 v22, s[8:11], s36 offen lds
s_add_u32 m0, m0, 1024
s_nop 0
buffer_load_dwordx4 v23, s[8:11], s36 offen lds
s_add_u32 m0, m0, 1024
s_nop 0
buffer_load_dwordx4 v24, s[8:11], s36 offen lds
s_add_u32 s36, s36, 122880
s_waitcnt vmcnt(5)
s_barrier
s_add_u32 m0, s37, 30720
s_nop 0
buffer_load_dwordx4 v20, s[8:11], s36 offen lds
s_add_u32 m0, m0, 1024
s_nop 0
buffer_load_dwordx4 v21, s[8:11], s36 offen lds
s_add_u32 m0, m0, 1024
s_nop 0
buffer_load_dwordx4 v22, s[8:11], s36 offen lds
s_add_u32 m0, m0, 1024
s_nop 0
buffer_load_dwordx4 v23, s[8:11], s36 offen lds
s_add_u32 m0, m0, 1024
s_nop 0
buffer_load_dwordx4 v24, s[8:11], s36 offen lds
s_add_u32 s36, s36, 122880
s_waitcnt vmcnt(5)
s_barrier
s_add_u32 m0, s37, 46080
s_nop 0
buffer_load_dwordx4 v20, s[8:11], s36 offen lds
s_add_u32 m0, m0, 1024
s_nop 0
buffer_load_dwordx4 v21, s[8:11], s36 offen lds
s_add_u32 m0, m0, 1024
s_nop 0
buffer_load_dwordx4 v22, s[8:11], s36 offen lds
s_add_u32 m0, m0, 1024
s_nop 0
buffer_load_dwordx4 v23, s[8:11], s36 offen lds
s_add_u32 m0, m0, 1024
s_nop 0
buffer_load_dwordx4 v24, s[8:11], s36 offen lds
s_add_u32 s36, s36, 122880
s_waitcnt vmcnt(5)
s_barrier
s_mov_b32 m0, s39
s_add_u32 s39, s39, 20480
buffer_load_dwordx4 v26, s[12:15], s38 offen offset:0 sc1 lds
buffer_load_dwordx4 v26, s[12:15], s38 offen offset:1024 sc1 lds
buffer_load_dwordx4 v26, s[12:15], s38 offen offset:2048 sc1 lds
buffer_load_dwordx4 v26, s[12:15], s38 offen offset:3072 sc1 lds
s_add_u32 m0, m0, 4096
s_add_u32 s38, s38, 4096
buffer_load_dwordx4 v26, s[12:15], s38 offen sc1 lds
s_add_u32 s38, s38, 16384
s_waitcnt vmcnt(5)
s_barrier
s_mov_b32 m0, s39
s_add_u32 s39, s39, 20480
buffer_load_dwordx4 v26, s[12:15], s38 offen offset:0 sc1 lds
buffer_load_dwordx4 v26, s[12:15], s38 offen offset:1024 sc1 lds
buffer_load_dwordx4 v26, s[12:15], s38 offen offset:2048 sc1 lds
buffer_load_dwordx4 v26, s[12:15], s38 offen offset:3072 sc1 lds
s_add_u32 m0, m0, 4096
s_add_u32 s38, s38, 4096
buffer_load_dwordx4 v26, s[12:15], s38 offen sc1 lds
s_add_u32 s38, s38, 16384
s_barrier
buffer_load_dwordx4 v[196:199], v26, s[12:15], s38 offen offset:0 sc1
buffer_load_dwordx4 v[200:203], v26, s[12:15], s38 offen offset:1024 sc1
buffer_load_dwordx4 v[204:207], v26, s[12:15], s38 offen offset:2048 sc1
buffer_load_dwordx4 v[208:211], v26, s[12:15], s38 offen offset:3072 sc1
s_add_u32 s38, s38, 4096
buffer_load_dwordx4 v[212:215], v26, s[12:15], s38 offen offset:0 sc1
s_add_u32 s38, s38, 16384
buffer_load_dwordx4 v[216:219], v26, s[12:15], s38 offen offset:0 sc1
buffer_load_dwordx4 v[220:223], v26, s[12:15], s38 offen offset:1024 sc1
buffer_load_dwordx4 v[224:227], v26, s[12:15], s38 offen offset:2048 sc1
buffer_load_dwordx4 v[228:231], v26, s[12:15], s38 offen offset:3072 sc1
s_add_u32 s38, s38, 4096
buffer_load_dwordx4 v[232:235], v26, s[12:15], s38 offen offset:0 sc1
s_add_u32 s38, s38, 16384
buffer_load_dwordx4 v[236:239], v26, s[12:15], s38 offen offset:0 sc1
buffer_load_dwordx4 v[240:243], v26, s[12:15], s38 offen offset:1024 sc1
buffer_load_dwordx4 v[244:247], v26, s[12:15], s38 offen offset:2048 sc1
buffer_load_dwordx4 v[248:251], v26, s[12:15], s38 offen offset:3072 sc1
s_add_u32 s38, s38, 4096
buffer_load_dwordx4 v[252:255], v26, s[12:15], s38 offen offset:0 sc1
s_add_u32 s38, s38, 16384
v_mov_b32 v16, 0
v_mov_b32 v17, 0
s_xor_b32 s27, s20, 4
s_or_b32 s27, s27, s48
s_cbranch_scc1 L_2_pk1
buffer_load_dwordx2 v[16:17], v76, s[12:15], s49 offen sc1
L_2_pk1:
s_waitcnt vmcnt(0)
v_cmp_ne_u64 vcc, s[96:97], v[16:17]
s_cbranch_vccnz L_2_nt1
s_mov_b32 s48, 1
s_mov_b32 m0, 102400
s_mov_b32 exec_hi, -1
buffer_load_dwordx4 v77, s[12:15], s40 offen sc1 lds
s_mov_b32 m0, 103424
s_nop 0
buffer_load_dwordx4 v78, s[12:15], s40 offen sc1 lds
s_mov_b32 m0, 104448
s_mov_b32 exec_hi, 0
buffer_load_dwordx4 v79, s[12:15], s40 offen sc1 lds
s_mov_b32 m0, 104976
s_mov_b32 exec_hi, -1
buffer_load_dwordx4 v77, s[12:15], s41 offen sc1 lds
s_mov_b32 m0, 106000
s_nop 0
buffer_load_dwordx4 v78, s[12:15], s41 offen sc1 lds
s_mov_b32 m0, 107024
s_mov_b32 exec_hi, 0
buffer_load_dwordx4 v79, s[12:15], s41 offen sc1 lds
s_mov_b32 m0, 107552
s_mov_b32 exec_hi, -1
buffer_load_dwordx4 v77, s[12:15], s42 offen sc1 lds
s_mov_b32 m0, 108576
s_nop 0
buffer_load_dwordx4 v78, s[12:15], s42 offen sc1 lds
s_mov_b32 m0, 109600
s_mov_b32 exec_hi, 0
buffer_load_dwordx4 v79, s[12:15], s42 offen sc1 lds
s_mov_b32 m0, 110128
s_mov_b32 exec_hi, -1
buffer_load_dwordx4 v77, s[12:15], s43 offen sc1 lds
s_mov_b32 m0, 111152
s_nop 0
buffer_load_dwordx4 v78, s[12:15], s43 offen sc1 lds
s_mov_b32 m0, 112176
s_mov_b32 exec_hi, 0
buffer_load_dwordx4 v79, s[12:15], s43 offen sc1 lds
s_mov_b32 exec_hi, -1
L_2_nt1:
s_branch L_a_fin
L_a_xl:
s_mov_b32 m0, 55296
s_add_u32 s37, s36, 128
buffer_load_dwordx4 v20, s[4:7], s37 offen lds
s_add_u32 m0, m0, 1024
s_add_u32 s37, s37, 20480
buffer_load_dwordx4 v21, s[4:7], s37 offen lds
s_add_u32 m0, m0, 1024
s_add_u32 s37, s37, 20480
buffer_load_dwordx4 v20, s[4:7], s37 offen lds
s_add_u32 m0, m0, 1024
s_add_u32 s37, s37, 20480
buffer_load_dwordx4 v21, s[4:7], s37 offen lds
s_add_u32 m0, m0, 1024
s_add_u32 s37, s37, 20480
buffer_load_dwordx4 v20, s[4:7], s37 offen lds
s_add_u32 m0, m0, 1024
s_add_u32 s37, s37, 20480
buffer_load_dwordx4 v21, s[4:7], s37 offen lds
s_add_u32 m0, m0, 1024
s_add_u32 s37, s37, 20480
buffer_load_dwordx4 v20, s[4:7], s37 offen lds
s_load_dwordx2 s[16:17], s[0:1], 80
s_mov_b32 s18, 256
s_load_dwordx2 s[92:93], s[0:1], 72
s_and_b32 s84, s22, 7
s_lshr_b32 s86, s22, 4
s_lshl_b32 s86, s86, 3
s_add_u32 s86, s86, s21
s_sub_u32 s87, 32, s86
s_cmp_eq_u32 s86, 0
s_cselect_b32 s87, 16, s87
s_bitcmp1_b32 s22, 3
s_cselect_b32 s85, s87, s86
s_mov_b32 s94, 2621440
s_mov_b32 s95, 0x20000
v_bfe_u32 v32, v0, 1, 3
v_lshrrev_b32 v33, 4, v0
s_sub_u32 s29, s20, 4
s_lshl_b32 s27, s29, 2
v_add_u32 v33, s27, v33
s_xor_b32 s28, s29, 3
s_lshl_b32 s28, s28, 3
s_add_u32 s28, s28, 149504
v_lshl_add_u32 v35, v32, 4, v33
v_mul_u32_u24 v9, 1440, v32
v_and_b32 v32, 1, v33
v_mul_u32_u24 v32, 10152, v32
v_mul_u32_u24 v33, 88, v33
v_add3_u32 v9, v9, v32, v33
v_lshl_add_u32 v12, v35, 5, s28
v_and_b32 v34, 1, v0
v_bfe_u32 v32, v0, 3, 0
v_lshl_add_u32 v9, v34, 4, v9
v_lshl_add_u32 v9, v32, 5, v9
v_add_u32 v9, 129024, v9
v_lshlrev_b32 v34, 4, v34
v_lshl_add_u32 v34, v32, 9, v34
s_cmp_eq_u32 s23, 0
s_cselect_b32 s28, 0, 7
s_sub_u32 s29, 1024, s26
s_min_u32 s29, s29, 112
s_waitcnt vmcnt(7)
s_barrier
s_mov_b32 m0, 62464
s_add_u32 s37, s36, 143488
s_cmp_eq_u32 s25, 0
s_cselect_b32 s27, 0x55555555, 0
buffer_load_dwordx4 v21, s[4:7], s37 offen lds
s_add_u32 m0, m0, 1024
s_add_u32 s37, s37, 20480
v_cmp_le_u32 vcc, s28, v35
v_cmp_gt_u32 s[30:31], s29, v35
buffer_load_dwordx4 v20, s[4:7], s37 offen lds
s_add_u32 m0, m0, 1024
s_add_u32 s37, s37, 20480
v_add_u32 v33, s26, v35
s_and_b64 vcc, vcc, s[30:31]
buffer_load_dwordx4 v21, s[4:7], s37 offen lds
s_add_u32 m0, m0, 1024
s_add_u32 s37, s37, 20480
v_lshl_add_u32 v33, v33, 1, s24
v_and_b32 v32, 31, v33
buffer_load_dwordx4 v20, s[4:7], s37 offen lds
s_add_u32 m0, m0, 1024
s_add_u32 s37, s37, 20480
v_mul_u32_u24 v10, 81920, v32
v_lshrrev_b32 v36, 5, v33
buffer_load_dwordx4 v21, s[4:7], s37 offen lds
s_add_u32 m0, m0, 1024
s_add_u32 s37, s37, 20480
v_lshl_add_u32 v36, v32, 6, v36
v_lshlrev_b32 v36, 2, v36
buffer_load_dwordx4 v20, s[4:7], s37 offen lds
s_add_u32 m0, m0, 1024
s_add_u32 s37, s37, 20480
v_lshrrev_b32 v32, 9, v33
v_mul_u32_u24 v32, 20480, v32
buffer_load_dwordx4 v21, s[4:7], s37 offen lds
s_waitcnt vmcnt(14)
s_barrier
s_mov_b32 m0, 69632
s_add_u32 s37, s36, 256
v_bfe_u32 v33, v33, 5, 4
v_lshl_add_u32 v32, v33, 5, v32
buffer_load_dwordx4 v20, s[4:7], s37 offen lds
s_add_u32 m0, m0, 1024
s_add_u32 s37, s37, 20480
v_add3_u32 v10, v10, v32, v34
v_mov_b32 v32, 1073741824
buffer_load_dwordx4 v21, s[4:7], s37 offen lds
s_add_u32 m0, m0, 1024
s_add_u32 s37, s37, 20480
v_cndmask_b32 v10, v32, v10, vcc
s_and_b32 vcc_lo, vcc_lo, s27
buffer_load_dwordx4 v20, s[4:7], s37 offen lds
s_add_u32 m0, m0, 1024
s_add_u32 s37, s37, 20480
s_and_b32 vcc_hi, vcc_hi, s27
v_add_u32 v35, 64, v35
buffer_load_dwordx4 v21, s[4:7], s37 offen lds
s_add_u32 m0, m0, 1024
s_add_u32 s37, s37, 20480
v_cndmask_b32 v36, v32, v36, vcc
s_mov_b32 s54, 2621440
buffer_load_dwordx4 v20, s[4:7], s37 offen lds
s_add_u32 m0, m0, 1024
s_add_u32 s37, s37, 20480
s_lshl_b32 s27, s23, 3
s_add_u32 s27, s27, s25
buffer_load_dwordx4 v21, s[4:7], s37 offen lds
s_add_u32 m0, m0, 1024
s_add_u32 s37, s37, 20480
s_add_u32 s29, s27, 0
s_and_b32 s29, s29, 3
s_cselect_b32 s29, 1073741824, 0
buffer_load_dwordx4 v20, s[4:7], s37 offen lds
s_waitcnt vmcnt(7)
s_barrier
s_mov_b32 m0, 76800
s_add_u32 s37, s36, 143616
s_lshr_b32 s27, s27, 2
s_lshl_b32 s28, s24, 7
buffer_load_dwordx4 v21, s[4:7], s37 offen lds
s_add_u32 m0, m0, 1024
s_add_u32 s37, s37, 20480
s_add_u32 s27, s27, s28
s_lshl_b32 s27, s27, 7
buffer_load_dwordx4 v20, s[4:7], s37 offen lds
s_add_u32 m0, m0, 1024
s_add_u32 s37, s37, 20480
s_add_u32 s27, s27, s29
s_add_u32 s55, s27, 5242880
buffer_load_dwordx4 v21, s[4:7], s37 offen lds
s_add_u32 m0, m0, 1024
s_add_u32 s37, s37, 20480
v_lshrrev_b32 v38, 3, v0
v_lshlrev_b32 v38, 15, v38
buffer_load_dwordx4 v20, s[4:7], s37 offen lds
s_add_u32 m0, m0, 1024
s_add_u32 s37, s37, 20480
v_and_b32 v33, 7, v0
v_cmp_gt_u32 vcc, 32, v0
buffer_load_dwordx4 v21, s[4:7], s37 offen lds
s_add_u32 m0, m0, 1024
s_add_u32 s37, s37, 20480
v_lshl_add_u32 v38, v33, 4, v38
s_mul_i32 s53, s25, 2560
buffer_load_dwordx4 v20, s[4:7], s37 offen lds
s_add_u32 m0, m0, 1024
s_add_u32 s37, s37, 20480
v_cndmask_b32 v38, v32, v38, vcc
s_add_u32 s53, s53, 0
buffer_load_dwordx4 v21, s[4:7], s37 offen lds
s_waitcnt vmcnt(14)
s_barrier
s_mov_b32 m0, 40960
s_add_u32 s37, s36, 384
v_lshlrev_b32 v26, 4, v0
s_sub_u32 s27, s20, 4
buffer_load_dwordx4 v20, s[4:7], s37 offen lds
s_add_u32 m0, m0, 1024
s_add_u32 s37, s37, 20480
s_mul_i32 s39, s27, 5120
s_mul_i32 s38, s84, 102400
buffer_load_dwordx4 v21, s[4:7], s37 offen lds
s_add_u32 m0, m0, 1024
s_add_u32 s37, s37, 20480
s_add_u32 s38, s38, s39
s_add_u32 s38, s38, 7340032
buffer_load_dwordx4 v20, s[4:7], s37 offen lds
s_add_u32 m0, m0, 1024
s_add_u32 s37, s37, 20480
v_lshlrev_b32 v76, 7, v0
s_lshl_b32 s49, s21, 13
buffer_load_dwordx4 v21, s[4:7], s37 offen lds
s_add_u32 m0, m0, 1024
s_add_u32 s37, s37, 20480
s_add_u32 s49, s49, 5373952
s_lshl_b32 s56, s21, 14
buffer_load_dwordx4 v20, s[4:7], s37 offen lds
s_add_u32 m0, m0, 1024
s_add_u32 s37, s37, 20480
s_add_u32 s56, s56, 5255168
s_mov_b32 s48, 0
buffer_load_dwordx4 v21, s[4:7], s37 offen lds
s_add_u32 m0, m0, 1024
s_add_u32 s37, s37, 20480
v_add_u32 v4, 0, v0
v_mul_u32_u24 v5, 13108, v4
buffer_load_dwordx4 v20, s[4:7], s37 offen lds
s_waitcnt vmcnt(7)
s_barrier
s_mov_b32 m0, 48128
s_add_u32 s37, s36, 143744
v_lshrrev_b32 v5, 16, v5
v_mul_u32_u24 v5, 57264, v5
buffer_load_dwordx4 v21, s[4:7], s37 offen lds
s_add_u32 m0, m0, 1024
s_add_u32 s37, s37, 20480
v_lshl_add_u32 v77, v4, 4, v5
v_add_u32 v4, 64, v0
buffer_load_dwordx4 v20, s[4:7], s37 offen lds
s_add_u32 m0, m0, 1024
s_add_u32 s37, s37, 20480
v_mul_u32_u24 v5, 13108, v4
v_lshrrev_b32 v5, 16, v5
buffer_load_dwordx4 v21, s[4:7], s37 offen lds
s_add_u32 m0, m0, 1024
s_add_u32 s37, s37, 20480
v_mul_u32_u24 v5, 57264, v5
v_lshl_add_u32 v78, v4, 4, v5
buffer_load_dwordx4 v20, s[4:7], s37 offen lds
s_add_u32 m0, m0, 1024
s_add_u32 s37, s37, 20480
v_add_u32 v4, 128, v0
v_mul_u32_u24 v5, 13108, v4
buffer_load_dwordx4 v21, s[4:7], s37 offen lds
s_add_u32 m0, m0, 1024
s_add_u32 s37, s37, 20480
v_lshrrev_b32 v5, 16, v5
v_mul_u32_u24 v5, 57264, v5
buffer_load_dwordx4 v20, s[4:7], s37 offen lds
s_add_u32 m0, m0, 1024
s_add_u32 s37, s37, 20480
v_lshl_add_u32 v79, v4, 4, v5
s_sub_u32 s28, 7, s84
buffer_load_dwordx4 v21, s[4:7], s37 offen lds
s_waitcnt vmcnt(14)
s_barrier
s_mov_b32 m0, 55296
s_add_u32 s37, s36, 512
s_sub_u32 s29, 32, s85
s_and_b32 s29, s29, 31
buffer_load_dwordx4 v20, s[4:7], s37 offen lds
s_add_u32 m0, m0, 1024
s_add_u32 s37, s37, 20480
s_lshl_b32 s43, s29, 3
s_add_u32 s43, s43, s28
buffer_load_dwordx4 v21, s[4:7], s37 offen lds
s_add_u32 m0, m0, 1024
s_add_u32 s37, s37, 20480
s_mul_i32 s43, s43, 80
s_add_u32 s43, s43, 3145728
buffer_load_dwordx4 v20, s[4:7], s37 offen lds
s_add_u32 m0, m0, 1024
s_add_u32 s37, s37, 20480
s_lshl_b32 s41, s85, 3
s_add_u32 s41, s41, s84
buffer_load_dwordx4 v21, s[4:7], s37 offen lds
s_add_u32 m0, m0, 1024
s_add_u32 s37, s37, 20480
s_mul_i32 s41, s41, 80
s_add_u32 s41, s41, 3145728
buffer_load_dwordx4 v20, s[4:7], s37 offen lds
s_add_u32 m0, m0, 1024
s_add_u32 s37, s37, 20480
s_cmp_ge_u32 s84, 4
s_cselect_b32 s28, s28, s84
s_cselect_b32 s29, s29, s85
s_cselect_b32 s40, 4, 0
buffer_load_dwordx4 v21, s[4:7], s37 offen lds
s_add_u32 m0, m0, 1024
s_add_u32 s37, s37, 20480
s_lshl_b32 s29, s29, 2
s_add_u32 s28, s28, s29
buffer_load_dwordx4 v20, s[4:7], s37 offen lds
s_waitcnt vmcnt(7)
s_barrier
s_mov_b32 m0, 62464
s_add_u32 s37, s36, 143872
s_mul_i32 s28, s28, 192
s_add_u32 s42, s28, 3178496
buffer_load_dwordx4 v21, s[4:7], s37 offen lds
s_add_u32 m0, m0, 1024
s_add_u32 s37, s37, 20480
s_add_u32 s40, s40, s42
s_add_u32 s40, s40, 80
buffer_load_dwordx4 v20, s[4:7], s37 offen lds
s_add_u32 m0, m0, 1024
s_add_u32 s37, s37, 20480
s_lshl_b32 s28, s20, 2
s_add_u32 s28, s28, 112800
buffer_load_dwordx4 v21, s[4:7], s37 offen lds
s_add_u32 m0, m0, 1024
s_add_u32 s37, s37, 20480
v_mov_b32 v80, s28
buffer_load_dwordx4 v20, s[4:7], s37 offen lds
s_add_u32 m0, m0, 1024
s_add_u32 s37, s37, 20480
buffer_load_dwordx4 v21, s[4:7], s37 offen lds
s_add_u32 m0, m0, 1024
s_add_u32 s37, s37, 20480
buffer_load_dwordx4 v20, s[4:7], s37 offen lds
s_add_u32 m0, m0, 1024
s_add_u32 s37, s37, 20480
buffer_load_dwordx4 v21, s[4:7], s37 offen lds
s_waitcnt vmcnt(14)
s_barrier
s_mov_b32 m0, 69632
s_add_u32 s37, s36, 640
buffer_load_dwordx4 v20, s[4:7], s37 offen lds
s_add_u32 m0, m0, 1024
s_add_u32 s37, s37, 20480
buffer_load_dwordx4 v21, s[4:7], s37 offen lds
s_add_u32 m0, m0, 1024
s_add_u32 s37, s37, 20480
buffer_load_dwordx4 v20, s[4:7], s37 offen lds
s_add_u32 m0, m0, 1024
s_add_u32 s37, s37, 20480
buffer_load_dwordx4 v21, s[4:7], s37 offen lds
s_add_u32 m0, m0, 1024
s_add_u32 s37, s37, 20480
buffer_load_dwordx4 v20, s[4:7], s37 offen lds
s_add_u32 m0, m0, 1024
s_add_u32 s37, s37, 20480
buffer_load_dwordx4 v21, s[4:7], s37 offen lds
s_add_u32 m0, m0, 1024
s_add_u32 s37, s37, 20480
buffer_load_dwordx4 v20, s[4:7], s37 offen lds
s_waitcnt vmcnt(7)
s_barrier
s_mov_b32 m0, 76800
s_add_u32 s37, s36, 144000
buffer_load_dwordx4 v21, s[4:7], s37 offen lds
s_add_u32 m0, m0, 1024
s_add_u32 s37, s37, 20480
buffer_load_dwordx4 v20, s[4:7], s37 offen lds
s_add_u32 m0, m0, 1024
s_add_u32 s37, s37, 20480
buffer_load_dwordx4 v21, s[4:7], s37 offen lds
s_add_u32 m0, m0, 1024
s_add_u32 s37, s37, 20480
buffer_load_dwordx4 v20, s[4:7], s37 offen lds
s_add_u32 m0, m0, 1024
s_add_u32 s37, s37, 20480
buffer_load_dwordx4 v21, s[4:7], s37 offen lds
s_add_u32 m0, m0, 1024
s_add_u32 s37, s37, 20480
buffer_load_dwordx4 v20, s[4:7], s37 offen lds
s_add_u32 m0, m0, 1024
s_add_u32 s37, s37, 20480
buffer_load_dwordx4 v21, s[4:7], s37 offen lds
s_waitcnt lgkmcnt(0)
s_load_dwordx2 s[96:97], s[16:17], 0
s_waitcnt vmcnt(14)
s_barrier
s_mov_b32 m0, 40960
s_add_u32 s37, s36, 768
buffer_load_dwordx4 v20, s[4:7], s37 offen lds
s_add_u32 m0, m0, 1024
s_add_u32 s37, s37, 20480
buffer_load_dwordx4 v21, s[4:7], s37 offen lds
s_add_u32 m0, m0, 1024
s_add_u32 s37, s37, 20480
buffer_load_dwordx4 v20, s[4:7], s37 offen lds
s_add_u32 m0, m0, 1024
s_add_u32 s37, s37, 20480
buffer_load_dwordx4 v21, s[4:7], s37 offen lds
s_add_u32 m0, m0, 1024
s_add_u32 s37, s37, 20480
buffer_load_dwordx4 v20, s[4:7], s37 offen lds
s_add_u32 m0, m0, 1024
s_add_u32 s37, s37, 20480
buffer_load_dwordx4 v21, s[4:7], s37 offen lds
s_add_u32 m0, m0, 1024
s_add_u32 s37, s37, 20480
buffer_load_dwordx4 v20, s[4:7], s37 offen lds
s_waitcnt vmcnt(7)
s_barrier
s_mov_b32 m0, 48128
s_add_u32 s37, s36, 144128
buffer_load_dwordx4 v21, s[4:7], s37 offen lds
s_add_u32 m0, m0, 1024
s_add_u32 s37, s37, 20480
buffer_load_dwordx4 v20, s[4:7], s37 offen lds
s_add_u32 m0, m0, 1024
s_add_u32 s37, s37, 20480
buffer_load_dwordx4 v21, s[4:7], s37 offen lds
s_add_u32 m0, m0, 1024
s_add_u32 s37, s37, 20480
buffer_load_dwordx4 v20, s[4:7], s37 offen lds
s_add_u32 m0, m0, 1024
s_add_u32 s37, s37, 20480
buffer_load_dwordx4 v21, s[4:7], s37 offen lds
s_add_u32 m0, m0, 1024
s_add_u32 s37, s37, 20480
buffer_load_dwordx4 v20, s[4:7], s37 offen lds
s_add_u32 m0, m0, 1024
s_add_u32 s37, s37, 20480
buffer_load_dwordx4 v21, s[4:7], s37 offen lds
s_waitcnt lgkmcnt(0)
s_cmp_lg_u32 s96, 0
s_cbranch_scc1 L_tg3
s_movk_i32 s59, 30000
v_mov_b32 v86, 0
L_th3:
s_sleep 8
buffer_load_dwordx2 v[84:85], v86, s[16:19], 0 offen sc1
s_waitcnt vmcnt(0)
v_readfirstlane_b32 s96, v84
v_readfirstlane_b32 s97, v85
s_sub_u32 s59, s59, 1
s_cbranch_scc1 L_tg3
s_cmp_eq_u32 s96, 0
s_cbranch_scc1 L_th3
s_nop 1
L_tg3:
s_waitcnt vmcnt(14)
s_barrier
s_mov_b32 m0, 55296
s_add_u32 s37, s36, 896
buffer_load_dwordx4 v20, s[4:7], s37 offen lds
s_add_u32 m0, m0, 1024
s_add_u32 s37, s37, 20480
buffer_load_dwordx4 v21, s[4:7], s37 offen lds
s_add_u32 m0, m0, 1024
s_add_u32 s37, s37, 20480
buffer_load_dwordx4 v20, s[4:7], s37 offen lds
s_add_u32 m0, m0, 1024
s_add_u32 s37, s37, 20480
buffer_load_dwordx4 v21, s[4:7], s37 offen lds
s_add_u32 m0, m0, 1024
s_add_u32 s37, s37, 20480
buffer_load_dwordx4 v20, s[4:7], s37 offen lds
s_add_u32 m0, m0, 1024
s_add_u32 s37, s37, 20480
buffer_load_dwordx4 v21, s[4:7], s37 offen lds
s_add_u32 m0, m0, 1024
s_add_u32 s37, s37, 20480
buffer_load_dwordx4 v20, s[4:7], s37 offen lds
s_waitcnt vmcnt(7)
s_barrier
s_mov_b32 m0, 62464
s_add_u32 s37, s36, 144256
buffer_load_dwordx4 v21, s[4:7], s37 offen lds
s_add_u32 m0, m0, 1024
s_add_u32 s37, s37, 20480
buffer_load_dwordx4 v20, s[4:7], s37 offen lds
s_add_u32 m0, m0, 1024
s_add_u32 s37, s37, 20480
buffer_load_dwordx4 v21, s[4:7], s37 offen lds
s_add_u32 m0, m0, 1024
s_add_u32 s37, s37, 20480
buffer_load_dwordx4 v20, s[4:7], s37 offen lds
s_add_u32 m0, m0, 1024
s_add_u32 s37, s37, 20480
buffer_load_dwordx4 v21, s[4:7], s37 offen lds
s_add_u32 m0, m0, 1024
s_add_u32 s37, s37, 20480
buffer_load_dwordx4 v20, s[4:7], s37 offen lds
s_add_u32 m0, m0, 1024
s_add_u32 s37, s37, 20480
buffer_load_dwordx4 v21, s[4:7], s37 offen lds
s_waitcnt vmcnt(14)
s_barrier
s_mov_b32 m0, 69632
s_add_u32 s37, s36, 1024
buffer_load_dwordx4 v20, s[4:7], s37 offen lds
s_add_u32 m0, m0, 1024
s_add_u32 s37, s37, 20480
buffer_load_dwordx4 v21, s[4:7], s37 offen lds
s_add_u32 m0, m0, 1024
s_add_u32 s37, s37, 20480
buffer_load_dwordx4 v20, s[4:7], s37 offen lds
s_add_u32 m0, m0, 1024
s_add_u32 s37, s37, 20480
buffer_load_dwordx4 v21, s[4:7], s37 offen lds
s_add_u32 m0, m0, 1024
s_add_u32 s37, s37, 20480
buffer_load_dwordx4 v20, s[4:7], s37 offen lds
s_add_u32 m0, m0, 1024
s_add_u32 s37, s37, 20480
buffer_load_dwordx4 v21, s[4:7], s37 offen lds
s_add_u32 m0, m0, 1024
s_add_u32 s37, s37, 20480
buffer_load_dwordx4 v20, s[4:7], s37 offen lds
s_waitcnt vmcnt(7)
s_barrier
s_mov_b32 m0, 76800
s_add_u32 s37, s36, 144384
buffer_load_dwordx4 v21, s[4:7], s37 offen lds
s_add_u32 m0, m0, 1024
s_add_u32 s37, s37, 20480
buffer_load_dwordx4 v20, s[4:7], s37 offen lds
s_add_u32 m0, m0, 1024
s_add_u32 s37, s37, 20480
buffer_load_dwordx4 v21, s[4:7], s37 offen lds
s_add_u32 m0, m0, 1024
s_add_u32 s37, s37, 20480
buffer_load_dwordx4 v20, s[4:7], s37 offen lds
s_add_u32 m0, m0, 1024
s_add_u32 s37, s37, 20480
buffer_load_dwordx4 v21, s[4:7], s37 offen lds
s_add_u32 m0, m0, 1024
s_add_u32 s37, s37, 20480
buffer_load_dwordx4 v20, s[4:7], s37 offen lds
s_add_u32 m0, m0, 1024
s_add_u32 s37, s37, 20480
buffer_load_dwordx4 v21, s[4:7], s37 offen lds
s_waitcnt vmcnt(14)
s_barrier
s_mov_b32 m0, 40960
s_add_u32 s37, s36, 1152
buffer_load_dwordx4 v20, s[4:7], s37 offen lds
s_add_u32 m0, m0, 1024
s_add_u32 s37, s37, 20480
buffer_load_dwordx4 v21, s[4:7], s37 offen lds
s_add_u32 m0, m0, 1024
s_add_u32 s37, s37, 20480
buffer_load_dwordx4 v20, s[4:7], s37 offen lds
s_add_u32 m0, m0, 1024
s_add_u32 s37, s37, 20480
buffer_load_dwordx4 v21, s[4:7], s37 offen lds
s_add_u32 m0, m0, 1024
s_add_u32 s37, s37, 20480
buffer_load_dwordx4 v20, s[4:7], s37 offen lds
s_add_u32 m0, m0, 1024
s_add_u32 s37, s37, 20480
buffer_load_dwordx4 v21, s[4:7], s37 offen lds
s_add_u32 m0, m0, 1024
s_add_u32 s37, s37, 20480
buffer_load_dwordx4 v20, s[4:7], s37 offen lds
s_waitcnt vmcnt(7)
s_barrier
s_lshl_b32 s57, s84, 7
s_add_u32 s57, s57, s56
s_load_dwordx2 s[28:29], s[12:13], s57
s_add_u32 s57, s57, 1024
s_load_dwordx2 s[30:31], s[12:13], s57
s_add_u32 s57, s57, 1024
s_load_dwordx2 s[44:45], s[12:13], s57
s_add_u32 s57, s57, 1024
s_load_dwordx2 s[46:47], s[12:13], s57
s_mov_b32 m0, 48128
s_add_u32 s37, s36, 144512
buffer_load_dwordx4 v21, s[4:7], s37 offen lds
s_add_u32 m0, m0, 1024
s_add_u32 s37, s37, 20480
buffer_load_dwordx4 v20, s[4:7], s37 offen lds
s_add_u32 m0, m0, 1024
s_add_u32 s37, s37, 20480
buffer_load_dwordx4 v21, s[4:7], s37 offen lds
s_add_u32 m0, m0, 1024
s_add_u32 s37, s37, 20480
buffer_load_dwordx4 v20, s[4:7], s37 offen lds
s_add_u32 m0, m0, 1024
s_add_u32 s37, s37, 20480
buffer_load_dwordx4 v21, s[4:7], s37 offen lds
s_add_u32 m0, m0, 1024
s_add_u32 s37, s37, 20480
buffer_load_dwordx4 v20, s[4:7], s37 offen lds
s_add_u32 m0, m0, 1024
s_add_u32 s37, s37, 20480
buffer_load_dwordx4 v21, s[4:7], s37 offen lds
s_waitcnt vmcnt(14)
s_barrier
s_waitcnt lgkmcnt(0)
s_xor_b64 s[28:29], s[28:29], s[96:97]
s_xor_b64 s[30:31], s[30:31], s[96:97]
s_xor_b64 s[44:45], s[44:45], s[96:97]
s_xor_b64 s[46:47], s[46:47], s[96:97]
s_or_b64 s[28:29], s[28:29], s[30:31]
s_or_b64 s[44:45], s[44:45], s[46:47]
s_or_b64 s[28:29], s[28:29], s[44:45]
s_cbranch_scc0 L_a_rdy
s_lshl_b32 s57, 0x01010101, s84
s_mov_b32 exec_lo, s57
s_mov_b32 exec_hi, 0
s_movk_i32 s59, 30000
L_pl4:
buffer_load_dwordx2 v[84:85], v76, s[12:15], s56 offen sc1
L_pm4:
s_sub_u32 s59, s59, 1
s_cbranch_scc1 L_pd4
s_waitcnt vmcnt(0)
v_cmp_ne_u64 vcc, s[96:97], v[84:85]
s_cbranch_vccz L_pd4
s_mov_b64 exec, vcc
s_sleep 4
s_branch L_pl4
L_pd4:
s_mov_b64 exec, -1
L_a_rdy:
s_waitcnt vmcnt(0)
s_barrier
s_mov_b32 m0, s39
s_add_u32 s39, s39, 20480
buffer_load_dwordx4 v26, s[12:15], s38 offen offset:0 sc1 lds
buffer_load_dwordx4 v26, s[12:15], s38 offen offset:1024 sc1 lds
buffer_load_dwordx4 v26, s[12:15], s38 offen offset:2048 sc1 lds
buffer_load_dwordx4 v26, s[12:15], s38 offen offset:3072 sc1 lds
s_add_u32 m0, m0, 4096
s_add_u32 s38, s38, 4096
buffer_load_dwordx4 v26, s[12:15], s38 offen sc1 lds
s_add_u32 s38, s38, 16384
s_waitcnt vmcnt(5)
s_barrier
s_mov_b32 m0, s39
s_add_u32 s39, s39, 20480
buffer_load_dwordx4 v26, s[12:15], s38 offen offset:0 sc1 lds
buffer_load_dwordx4 v26, s[12:15], s38 offen offset:1024 sc1 lds
buffer_load_dwordx4 v26, s[12:15], s38 offen offset:2048 sc1 lds
buffer_load_dwordx4 v26, s[12:15], s38 offen offset:3072 sc1 lds
s_add_u32 m0, m0, 4096
s_add_u32 s38, s38, 4096
buffer_load_dwordx4 v26, s[12:15], s38 offen sc1 lds
s_add_u32 s38, s38, 16384
s_barrier
buffer_load_dwordx4 v[196:199], v26, s[12:15], s38 offen offset:0 sc1
buffer_load_dwordx4 v[200:203], v26, s[12:15], s38 offen offset:1024 sc1
buffer_load_dwordx4 v[204:207], v26, s[12:15], s38 offen offset:2048 sc1
buffer_load_dwordx4 v[208:211], v26, s[12:15], s38 offen offset:3072 sc1
s_add_u32 s38, s38, 4096
buffer_load_dwordx4 v[212:215], v26, s[12:15], s38 offen offset:0 sc1
s_add_u32 s38, s38, 16384
buffer_load_dwordx4 v[216:219], v26, s[12:15], s38 offen offset:0 sc1
buffer_load_dwordx4 v[220:223], v26, s[12:15], s38 offen offset:1024 sc1
buffer_load_dwordx4 v[224:227], v26, s[12:15], s38 offen offset:2048 sc1
buffer_load_dwordx4 v[228:231], v26, s[12:15], s38 offen offset:3072 sc1
s_add_u32 s38, s38, 4096
buffer_load_dwordx4 v[232:235], v26, s[12:15], s38 offen offset:0 sc1
s_add_u32 s38, s38, 16384
buffer_load_dwordx4 v[236:239], v26, s[12:15], s38 offen offset:0 sc1
buffer_load_dwordx4 v[240:243], v26, s[12:15], s38 offen offset:1024 sc1
buffer_load_dwordx4 v[244:247], v26, s[12:15], s38 offen offset:2048 sc1
buffer_load_dwordx4 v[248:251], v26, s[12:15], s38 offen offset:3072 sc1
s_add_u32 s38, s38, 4096
buffer_load_dwordx4 v[252:255], v26, s[12:15], s38 offen offset:0 sc1
s_add_u32 s38, s38, 16384
s_add_u32 s57, s49, 131072
s_mov_b32 exec_hi, 0
buffer_load_dwordx2 v[84:85], v76, s[12:15], s57 offen sc1
s_mov_b32 exec_hi, -1
s_waitcnt vmcnt(0)
s_mov_b32 exec_hi, 0
v_cmp_ne_u64 vcc, s[96:97], v[84:85]
s_mov_b32 exec_hi, -1
s_cbranch_vccz L_a_mk
s_mov_b32 exec_lo, -1
s_mov_b32 exec_hi, 0
s_movk_i32 s59, 30000
L_pl5:
buffer_load_dwordx2 v[84:85], v76, s[12:15], s57 offen sc1
L_pm5:
s_sub_u32 s59, s59, 1
s_cbranch_scc1 L_pd5
s_waitcnt vmcnt(0)
v_cmp_ne_u64 vcc, s[96:97], v[84:85]
s_cbranch_vccz L_pd5
s_mov_b64 exec, vcc
s_sleep 2
s_branch L_pl5
L_pd5:
s_mov_b64 exec, -1
L_a_mk:
L_a_fin:
v_mov_b32 v2, 112800
v_mov_b32 v4, 0
ds_write_b32 v80, v4
ds_write_b32 v80, v4 offset:16
ds_write_b32 v2, v4
ds_write_b32 v2, v4 offset:8
s_cmp_lg_u32 s20, 7
s_cbranch_scc1 L_a_hy
v_mov_b32 v86, 149496
s_mov_b32 s59, 131072
L_a_hw:
ds_read_b32 v87, v86
s_sub_u32 s59, s59, 1
s_cbranch_scc1 L_a_hx
s_waitcnt lgkmcnt(0)
v_cmp_eq_u32 vcc, 0, v87
s_cbranch_vccz L_a_hx
s_sleep 1
s_branch L_a_hw
L_a_hx:
v_mov_b32 v84, s96
v_mov_b32 v85, s97
v_mov_b32 v86, s96
v_mov_b32 v87, s97
buffer_store_dwordx4 v[84:87], v38, s[12:15], s55 offen sc1
L_a_hy:
s_setprio 2
s_waitcnt lgkmcnt(0)
s_barrier
ds_read_b128 v[100:103], v9 offset:0
ds_read_b128 v[104:107], v9 offset:32
ds_read_b128 v[108:111], v9 offset:64
ds_read_b128 v[112:115], v9 offset:96
ds_read_b128 v[116:119], v9 offset:128
ds_read_b32 v120, v12 offset:0
v_mov_b32 v16, 0
v_mov_b32 v17, 0
s_xor_b32 s27, s20, 4
s_or_b32 s27, s27, s48
s_cbranch_scc1 L_2_pk2
buffer_load_dwordx2 v[16:17], v76, s[12:15], s49 offen sc1
L_2_pk2:
s_waitcnt lgkmcnt(5)
buffer_store_dwordx4 v[100:103], v10, s[12:15], s53 offen offset:0 sc1
s_waitcnt lgkmcnt(4)
buffer_store_dwordx4 v[104:107], v10, s[12:15], s53 offen offset:512 sc1
s_waitcnt lgkmcnt(3)
buffer_store_dwordx4 v[108:111], v10, s[12:15], s53 offen offset:1024 sc1
s_waitcnt lgkmcnt(2)
buffer_store_dwordx4 v[112:115], v10, s[12:15], s53 offen offset:1536 sc1
s_waitcnt lgkmcnt(1)
buffer_store_dwordx4 v[116:119], v10, s[12:15], s53 offen offset:2048 sc1
s_cmp_lg_u32 s25, 0
s_cbranch_scc1 L_a_nz0
s_waitcnt lgkmcnt(0)
buffer_store_dword v120, v36, s[12:15], s54 offen sc1
L_a_nz0:
s_mov_b64 exec, -1
s_setprio 0
s_waitcnt vmcnt(5) lgkmcnt(0)
s_cmp_eq_u32 s48, 0
s_cbranch_scc1 L_a_nlf
ds_write_b32 v2, v2
L_a_nlf:
v_cmp_ne_u64 vcc, s[96:97], v[16:17]
s_cbranch_vccnz L_2_nt2
s_mov_b32 s48, 2
s_mov_b32 m0, 102400
s_mov_b32 exec_hi, -1
buffer_load_dwordx4 v77, s[12:15], s40 offen sc1 lds
s_mov_b32 m0, 103424
s_nop 0
buffer_load_dwordx4 v78, s[12:15], s40 offen sc1 lds
s_mov_b32 m0, 104448
s_mov_b32 exec_hi, 0
buffer_load_dwordx4 v79, s[12:15], s40 offen sc1 lds
s_mov_b32 m0, 104976
s_mov_b32 exec_hi, -1
buffer_load_dwordx4 v77, s[12:15], s41 offen sc1 lds
s_mov_b32 m0, 106000
s_nop 0
buffer_load_dwordx4 v78, s[12:15], s41 offen sc1 lds
s_mov_b32 m0, 107024
s_mov_b32 exec_hi, 0
buffer_load_dwordx4 v79, s[12:15], s41 offen sc1 lds
s_mov_b32 m0, 107552
s_mov_b32 exec_hi, -1
buffer_load_dwordx4 v77, s[12:15], s42 offen sc1 lds
s_mov_b32 m0, 108576
s_nop 0
buffer_load_dwordx4 v78, s[12:15], s42 offen sc1 lds
s_mov_b32 m0, 109600
s_mov_b32 exec_hi, 0
buffer_load_dwordx4 v79, s[12:15], s42 offen sc1 lds
s_mov_b32 m0, 110128
s_mov_b32 exec_hi, -1
buffer_load_dwordx4 v77, s[12:15], s43 offen sc1 lds
s_mov_b32 m0, 111152
s_nop 0
buffer_load_dwordx4 v78, s[12:15], s43 offen sc1 lds
s_mov_b32 m0, 112176
s_mov_b32 exec_hi, 0
buffer_load_dwordx4 v79, s[12:15], s43 offen sc1 lds
s_mov_b32 exec_hi, -1
L_2_nt2:
s_mov_b32 s59, 262144
L_a_pw:
ds_read_b32 v4, v80
s_sub_u32 s59, s59, 1
s_cbranch_scc1 L_a_px
s_waitcnt lgkmcnt(0)
v_cmp_eq_u32 vcc, 0, v4
s_cbranch_vccnz L_a_pw
L_a_px:
v_add_u32 v26, s39, v26
v_add_u32 v27, 61440, v26
ds_write_b128 v26, v[196:199] offset:0
ds_write_b128 v26, v[200:203] offset:1024
ds_write_b128 v26, v[204:207] offset:2048
ds_write_b128 v26, v[208:211] offset:3072
ds_write_b128 v26, v[212:215] offset:4096
ds_write_b128 v26, v[216:219] offset:20480
ds_write_b128 v26, v[220:223] offset:21504
ds_write_b128 v26, v[224:227] offset:22528
ds_write_b128 v26, v[228:231] offset:23552
ds_write_b128 v26, v[232:235] offset:24576
ds_write_b128 v26, v[236:239] offset:40960
ds_write_b128 v26, v[240:243] offset:41984
ds_write_b128 v26, v[244:247] offset:43008
ds_write_b128 v26, v[248:251] offset:44032
ds_write_b128 v26, v[252:255] offset:45056
ds_write_b32 v80, v2 offset:16
s_setprio 0
s_branch L_2_lb
L_a_comp:
s_load_dwordx2 s[16:17], s[0:1], 80
s_mov_b32 s18, 256
v_mov_b32 v38, 149496
v_mov_b32 v249, 0
v_mov_b32 v251, 0
v_mov_b32 v253, 0
s_mov_b32 s28, 149504
v_lshl_add_u32 v247, v242, 2, s28
v_and_b32 v240, 15, v0
v_lshrrev_b32 v241, 4, v0
v_lshrrev_b32 v242, 1, v240
v_xor_b32 v242, v242, v241
v_lshlrev_b32 v242, 4, v242
v_lshl_add_u32 v2, v240, 7, v242
v_add_u32 v2, 40960, v2
v_xor_b32 v3, 64, v2
v_lshrrev_b32 v242, 5, v0
v_bfe_u32 v243, v0, 2, 3
v_lshl_add_u32 v242, v242, 4, v243
v_mul_u32_u24 v242, 480, v242
s_mul_i32 s27, s20, 40
s_add_u32 s28, s27, 83968
v_add_u32 v242, s28, v242
v_and_b32 v243, 3, v0
v_lshl_add_u32 v4, v243, 3, v242
v_add_u32 v5, 46080, v4
v_cmp_eq_u32 vcc, 3, v243
v_mul_u32_u24 v243, 160, v243
v_add3_u32 v6, v242, v243, 32
v_add_u32 v7, 3840, v6
v_bfe_u32 v242, v0, 2, 2
v_lshl_add_u32 v242, v241, 3, v242
v_lshlrev_b32 v242, 3, v242
v_add_u32 v242, 149504, v242
v_cndmask_b32 v6, v6, v242, vcc
v_add_u32 v242, 32, v242
v_cndmask_b32 v7, v7, v242, vcc
v_mov_b32 v242, 0x100
v_mov_b32 v14, 15360
v_mov_b32 v15, -46080
v_cndmask_b32 v14, v14, v242, vcc
v_cndmask_b32 v15, v15, v242, vcc
s_load_dwordx2 s[92:93], s[0:1], 72
s_and_b32 s84, s22, 7
s_lshr_b32 s86, s22, 4
s_lshl_b32 s86, s86, 3
s_add_u32 s86, s86, s21
s_sub_u32 s87, 32, s86
s_cmp_eq_u32 s86, 0
s_cselect_b32 s87, 16, s87
s_bitcmp1_b32 s22, 3
s_cselect_b32 s85, s87, s86
s_mov_b32 s94, 2621440
s_mov_b32 s95, 0x20000
s_mul_i32 s28, s20, 3584
s_add_u32 s28, s28, 149504
v_lshrrev_b32 v242, 2, v240
v_lshl_add_u32 v243, v240, 5, s28
v_xor_b32 v8, v242, v241
v_lshl_add_u32 v8, v8, 3, v243
v_xor_b32 v13, 1, v242
v_lshl_add_u32 v13, v13, 3, v243
v_and_b32 v242, 60, v0
v_xor_b32 v243, 2, v241
v_or_b32 v242, v242, v243
v_lshl_add_u32 v9, v242, 3, s28
v_and_b32 v243, 1, v240
v_mul_u32_u24 v243, 10152, v243
v_mul_u32_u24 v242, 88, v240
v_add_u32 v242, v242, v243
v_lshl_add_u32 v242, v241, 3, v242
s_add_u32 s28, s27, 129024
v_add_u32 v10, s28, v242
v_mul_u32_u24 v242, 1432, v241
v_add3_u32 v11, v10, v242, 32
v_lshlrev_b32 v242, 2, v241
v_sub_u32 v242, v242, v240
v_mov_b32 v30, 0xf149f2ca
v_mov_b32 v31, 0
v_add_u32 v243, 7, v242
v_cmp_gt_u32 vcc, 8, v243
v_cmp_le_i32 s[30:31], 16, v243
v_mov_b32 v32, 0x3f803f80
v_cndmask_b32 v16, v30, v31, vcc
v_cndmask_b32 v20, v30, v31, s[30:31]
v_add_u32 v243, 8, v242
v_cmp_gt_u32 vcc, 8, v243
v_cmp_le_i32 s[30:31], 16, v243
v_mov_b32 v33, 0x3f803f80
v_cndmask_b32 v17, v30, v31, vcc
v_cndmask_b32 v21, v30, v31, s[30:31]
v_add_u32 v243, 9, v242
v_cmp_gt_u32 vcc, 8, v243
v_cmp_le_i32 s[30:31], 16, v243
v_mov_b32 v34, 0x3f803f80
v_cndmask_b32 v18, v30, v31, vcc
v_cndmask_b32 v22, v30, v31, s[30:31]
v_add_u32 v243, 10, v242
v_cmp_gt_u32 vcc, 8, v243
v_cmp_le_i32 s[30:31], 16, v243
v_mov_b32 v35, 0x3f803f80
v_cndmask_b32 v19, v30, v31, vcc
v_cndmask_b32 v23, v30, v31, s[30:31]
v_cndmask_b32 v24, 0, -1, s[30:31]
v_cmp_gt_u32 vcc, 16, v0
v_not_b32 v25, v24
s_nop 0
v_cndmask_b32 v28, 0, -1, vcc
v_mov_b32 v30, 0xff61b1e6
v_cndmask_b32 v16, v16, v30, s[30:31]
v_cndmask_b32 v20, v30, v20, s[30:31]
v_cndmask_b32 v17, v17, v30, s[30:31]
v_cndmask_b32 v21, v30, v21, s[30:31]
v_cndmask_b32 v18, v18, v30, s[30:31]
v_cndmask_b32 v22, v30, v22, s[30:31]
v_cndmask_b32 v19, v19, v30, s[30:31]
v_cndmask_b32 v23, v30, v23, s[30:31]
v_and_b32 v27, 0x3ff00000, v25
v_mov_b32 v26, 0
v_and_b32 v25, 0x3ff00000, v24
v_mov_b32 v24, 0
v_and_b32 v37, 0x3ff00000, v28
v_mov_b32 v36, 0
v_lshlrev_b32 v29, 7, v0
s_lshl_b32 s47, s21, 14
s_add_u32 s47, s47, 5242880
s_add_u32 s58, s47, 5120
s_mov_b32 s32, 0x3ea52b5c
s_mov_b32 s33, 0x3ea52b5c
s_mov_b32 s34, 0xbea52b5c
s_waitcnt vmcnt(0)
ds_write_b64 v247, v[248:249] offset:0
ds_write_b64 v247, v[250:251] offset:2048
ds_write_b64 v247, v[252:253] offset:4096
ds_write2_b32 v38, v249, v249 offset1:1
s_waitcnt lgkmcnt(0)
s_barrier
ds_read_b128 v[40:43], v2 offset:0
ds_read_b64_tr_b16 v[68:69], v4 offset:0
ds_read_b64_tr_b16 v[70:71], v4 offset:3840
ds_read_b64_tr_b16 v[72:73], v4 offset:160
ds_read_b64_tr_b16 v[74:75], v4 offset:4000
ds_read_b64_tr_b16 v[76:77], v6
ds_read_b64_tr_b16 v[78:79], v7
ds_read_b64_tr_b16 v[80:81], v4 offset:320
ds_read_b64_tr_b16 v[82:83], v4 offset:4160
ds_read_b128 v[44:47], v2 offset:2048
ds_read_b128 v[48:51], v2 offset:4096
ds_read_b128 v[52:55], v2 offset:6144
ds_read_b128 v[56:59], v2 offset:8192
ds_read_b128 v[60:63], v2 offset:10240
ds_read_b128 v[64:67], v2 offset:12288
v_add_u32_e64 v6, v6, v14
v_add_u32_e64 v7, v7, v14
.p2align 3
s_waitcnt lgkmcnt(0)
s_barrier
v_mfma_f32_16x16x32_bf16 v[136:139], v[76:79], v[40:43], 0
ds_read_b128 v[84:87], v3 offset:0
v_mfma_f32_16x16x32_bf16 v[128:131], v[68:71], v[40:43], 0
ds_read_b64_tr_b16 v[112:113], v4 offset:15360
v_mfma_f32_16x16x32_bf16 v[132:135], v[72:75], v[40:43], 0
ds_read_b64_tr_b16 v[114:115], v4 offset:19200
v_mfma_f32_16x16x32_bf16 v[140:143], v[40:43], v[80:83], 0
ds_read_b64_tr_b16 v[116:117], v4 offset:15520
v_mfma_f32_16x16x32_bf16 v[152:155], v[76:79], v[44:47], 0
ds_read_b64_tr_b16 v[118:119], v4 offset:19360
v_mfma_f32_16x16x32_bf16 v[144:147], v[68:71], v[44:47], 0
ds_read_b64_tr_b16 v[120:121], v6
v_mfma_f32_16x16x32_bf16 v[148:151], v[72:75], v[44:47], 0
ds_read_b64_tr_b16 v[122:123], v7
v_mfma_f32_16x16x32_bf16 v[156:159], v[44:47], v[80:83], 0
ds_read_b64_tr_b16 v[124:125], v4 offset:15680
v_mfma_f32_16x16x32_bf16 v[168:171], v[76:79], v[48:51], 0
ds_read_b64_tr_b16 v[126:127], v4 offset:19520
v_mfma_f32_16x16x32_bf16 v[160:163], v[68:71], v[48:51], 0
ds_read_b128 v[88:91], v3 offset:2048
v_mfma_f32_16x16x32_bf16 v[164:167], v[72:75], v[48:51], 0
ds_read_b128 v[92:95], v3 offset:4096
v_mfma_f32_16x16x32_bf16 v[172:175], v[48:51], v[80:83], 0
ds_read_b128 v[96:99], v3 offset:6144
v_mfma_f32_16x16x32_bf16 v[184:187], v[76:79], v[52:55], 0
ds_read_b128 v[100:103], v3 offset:8192
v_mfma_f32_16x16x32_bf16 v[176:179], v[68:71], v[52:55], 0
ds_read_b128 v[104:107], v3 offset:10240
v_mfma_f32_16x16x32_bf16 v[180:183], v[72:75], v[52:55], 0
ds_read_b128 v[108:111], v3 offset:12288
v_mfma_f32_16x16x32_bf16 v[188:191], v[52:55], v[80:83], 0
v_add_u32_e64 v6, v6, v14
v_mfma_f32_16x16x32_bf16 v[200:203], v[76:79], v[56:59], 0
v_add_u32_e64 v7, v7, v14
v_mfma_f32_16x16x32_bf16 v[192:195], v[68:71], v[56:59], 0
v_mfma_f32_16x16x32_bf16 v[196:199], v[72:75], v[56:59], 0
v_mfma_f32_16x16x32_bf16 v[204:207], v[56:59], v[80:83], 0
v_mfma_f32_16x16x32_bf16 v[216:219], v[76:79], v[60:63], 0
v_mfma_f32_16x16x32_bf16 v[208:211], v[68:71], v[60:63], 0
v_mfma_f32_16x16x32_bf16 v[212:215], v[72:75], v[60:63], 0
v_mfma_f32_16x16x32_bf16 v[220:223], v[60:63], v[80:83], 0
v_mfma_f32_16x16x32_bf16 v[232:235], v[76:79], v[64:67], 0
v_mfma_f32_16x16x32_bf16 v[224:227], v[68:71], v[64:67], 0
v_mfma_f32_16x16x32_bf16 v[228:231], v[72:75], v[64:67], 0
v_mfma_f32_16x16x32_bf16 v[236:239], v[64:67], v[80:83], 0
s_waitcnt lgkmcnt(0)
s_barrier
v_mfma_f32_16x16x32_bf16 v[136:139], v[120:123], v[84:87], v[136:139]
ds_read_b128 v[40:43], v2 offset:14336
v_mfma_f32_16x16x32_bf16 v[128:131], v[112:115], v[84:87], v[128:131]
ds_read_b64_tr_b16 v[68:69], v4 offset:30720
v_mfma_f32_16x16x32_bf16 v[132:135], v[116:119], v[84:87], v[132:135]
ds_read_b64_tr_b16 v[70:71], v4 offset:34560
v_mfma_f32_16x16x32_bf16 v[140:143], v[84:87], v[124:127], v[140:143]
ds_read_b64_tr_b16 v[72:73], v4 offset:30880
v_mfma_f32_16x16x32_bf16 v[152:155], v[120:123], v[88:91], v[152:155]
ds_read_b64_tr_b16 v[74:75], v4 offset:34720
v_mfma_f32_16x16x32_bf16 v[144:147], v[112:115], v[88:91], v[144:147]
ds_read_b64_tr_b16 v[76:77], v6
v_mfma_f32_16x16x32_bf16 v[148:151], v[116:119], v[88:91], v[148:151]
ds_read_b64_tr_b16 v[78:79], v7
v_mfma_f32_16x16x32_bf16 v[156:159], v[88:91], v[124:127], v[156:159]
ds_read_b64_tr_b16 v[80:81], v4 offset:31040
v_mfma_f32_16x16x32_bf16 v[168:171], v[120:123], v[92:95], v[168:171]
ds_read_b64_tr_b16 v[82:83], v4 offset:34880
v_mfma_f32_16x16x32_bf16 v[160:163], v[112:115], v[92:95], v[160:163]
ds_read_b128 v[44:47], v2 offset:16384
v_mfma_f32_16x16x32_bf16 v[164:167], v[116:119], v[92:95], v[164:167]
ds_read_b128 v[48:51], v2 offset:18432
v_mfma_f32_16x16x32_bf16 v[172:175], v[92:95], v[124:127], v[172:175]
ds_read_b128 v[52:55], v2 offset:20480
v_mfma_f32_16x16x32_bf16 v[184:187], v[120:123], v[96:99], v[184:187]
ds_read_b128 v[56:59], v2 offset:22528
v_mfma_f32_16x16x32_bf16 v[176:179], v[112:115], v[96:99], v[176:179]
ds_read_b128 v[60:63], v2 offset:24576
v_mfma_f32_16x16x32_bf16 v[180:183], v[116:119], v[96:99], v[180:183]
ds_read_b128 v[64:67], v2 offset:26624
v_mfma_f32_16x16x32_bf16 v[188:191], v[96:99], v[124:127], v[188:191]
v_add_u32_e64 v6, v6, v14
v_mfma_f32_16x16x32_bf16 v[200:203], v[120:123], v[100:103], v[200:203]
v_add_u32_e64 v7, v7, v14
v_mfma_f32_16x16x32_bf16 v[192:195], v[112:115], v[100:103], v[192:195]
v_mfma_f32_16x16x32_bf16 v[196:199], v[116:119], v[100:103], v[196:199]
v_mfma_f32_16x16x32_bf16 v[204:207], v[100:103], v[124:127], v[204:207]
v_mfma_f32_16x16x32_bf16 v[216:219], v[120:123], v[104:107], v[216:219]
v_mfma_f32_16x16x32_bf16 v[208:211], v[112:115], v[104:107], v[208:211]
v_mfma_f32_16x16x32_bf16 v[212:215], v[116:119], v[104:107], v[212:215]
v_mfma_f32_16x16x32_bf16 v[220:223], v[104:107], v[124:127], v[220:223]
v_mfma_f32_16x16x32_bf16 v[232:235], v[120:123], v[108:111], v[232:235]
v_mfma_f32_16x16x32_bf16 v[224:227], v[112:115], v[108:111], v[224:227]
v_mfma_f32_16x16x32_bf16 v[228:231], v[116:119], v[108:111], v[228:231]
v_mfma_f32_16x16x32_bf16 v[236:239], v[108:111], v[124:127], v[236:239]
s_waitcnt lgkmcnt(0)
s_barrier
v_mfma_f32_16x16x32_bf16 v[136:139], v[76:79], v[40:43], v[136:139]
ds_read_b128 v[84:87], v3 offset:14336
v_mfma_f32_16x16x32_bf16 v[128:131], v[68:71], v[40:43], v[128:131]
ds_read_b64_tr_b16 v[112:113], v5 offset:0
v_mfma_f32_16x16x32_bf16 v[132:135], v[72:75], v[40:43], v[132:135]
ds_read_b64_tr_b16 v[114:115], v5 offset:3840
v_mfma_f32_16x16x32_bf16 v[140:143], v[40:43], v[80:83], v[140:143]
ds_read_b64_tr_b16 v[116:117], v5 offset:160
v_mfma_f32_16x16x32_bf16 v[152:155], v[76:79], v[44:47], v[152:155]
ds_read_b64_tr_b16 v[118:119], v5 offset:4000
v_mfma_f32_16x16x32_bf16 v[144:147], v[68:71], v[44:47], v[144:147]
ds_read_b64_tr_b16 v[120:121], v6
v_mfma_f32_16x16x32_bf16 v[148:151], v[72:75], v[44:47], v[148:151]
ds_read_b64_tr_b16 v[122:123], v7
v_mfma_f32_16x16x32_bf16 v[156:159], v[44:47], v[80:83], v[156:159]
ds_read_b64_tr_b16 v[124:125], v5 offset:320
v_mfma_f32_16x16x32_bf16 v[168:171], v[76:79], v[48:51], v[168:171]
ds_read_b64_tr_b16 v[126:127], v5 offset:4160
v_mfma_f32_16x16x32_bf16 v[160:163], v[68:71], v[48:51], v[160:163]
ds_read_b128 v[88:91], v3 offset:16384
v_mfma_f32_16x16x32_bf16 v[164:167], v[72:75], v[48:51], v[164:167]
ds_read_b128 v[92:95], v3 offset:18432
v_mfma_f32_16x16x32_bf16 v[172:175], v[48:51], v[80:83], v[172:175]
ds_read_b128 v[96:99], v3 offset:20480
v_mfma_f32_16x16x32_bf16 v[184:187], v[76:79], v[52:55], v[184:187]
ds_read_b128 v[100:103], v3 offset:22528
v_mfma_f32_16x16x32_bf16 v[176:179], v[68:71], v[52:55], v[176:179]
ds_read_b128 v[104:107], v3 offset:24576
v_mfma_f32_16x16x32_bf16 v[180:183], v[72:75], v[52:55], v[180:183]
ds_read_b128 v[108:111], v3 offset:26624
v_mfma_f32_16x16x32_bf16 v[188:191], v[52:55], v[80:83], v[188:191]
v_add_u32_e64 v6, v6, v15
v_mfma_f32_16x16x32_bf16 v[200:203], v[76:79], v[56:59], v[200:203]
v_add_u32_e64 v7, v7, v15
v_mfma_f32_16x16x32_bf16 v[192:195], v[68:71], v[56:59], v[192:195]
v_mfma_f32_16x16x32_bf16 v[196:199], v[72:75], v[56:59], v[196:199]
v_mfma_f32_16x16x32_bf16 v[204:207], v[56:59], v[80:83], v[204:207]
v_mfma_f32_16x16x32_bf16 v[216:219], v[76:79], v[60:63], v[216:219]
v_mfma_f32_16x16x32_bf16 v[208:211], v[68:71], v[60:63], v[208:211]
v_mfma_f32_16x16x32_bf16 v[212:215], v[72:75], v[60:63], v[212:215]
v_mfma_f32_16x16x32_bf16 v[220:223], v[60:63], v[80:83], v[220:223]
v_mfma_f32_16x16x32_bf16 v[232:235], v[76:79], v[64:67], v[232:235]
v_mfma_f32_16x16x32_bf16 v[224:227], v[68:71], v[64:67], v[224:227]
v_mfma_f32_16x16x32_bf16 v[228:231], v[72:75], v[64:67], v[228:231]
v_mfma_f32_16x16x32_bf16 v[236:239], v[64:67], v[80:83], v[236:239]
s_waitcnt lgkmcnt(0)
s_barrier
v_mfma_f32_16x16x32_bf16 v[136:139], v[120:123], v[84:87], v[136:139]
ds_read_b128 v[40:43], v2 offset:28672
v_mfma_f32_16x16x32_bf16 v[128:131], v[112:115], v[84:87], v[128:131]
ds_read_b64_tr_b16 v[68:69], v4 offset:0
v_mfma_f32_16x16x32_bf16 v[132:135], v[116:119], v[84:87], v[132:135]
ds_read_b64_tr_b16 v[70:71], v4 offset:3840
v_mfma_f32_16x16x32_bf16 v[140:143], v[84:87], v[124:127], v[140:143]
ds_read_b64_tr_b16 v[72:73], v4 offset:160
v_mfma_f32_16x16x32_bf16 v[152:155], v[120:123], v[88:91], v[152:155]
ds_read_b64_tr_b16 v[74:75], v4 offset:4000
v_mfma_f32_16x16x32_bf16 v[144:147], v[112:115], v[88:91], v[144:147]
ds_read_b64_tr_b16 v[76:77], v6
v_mfma_f32_16x16x32_bf16 v[148:151], v[116:119], v[88:91], v[148:151]
ds_read_b64_tr_b16 v[78:79], v7
v_mfma_f32_16x16x32_bf16 v[156:159], v[88:91], v[124:127], v[156:159]
ds_read_b64_tr_b16 v[80:81], v4 offset:320
v_mfma_f32_16x16x32_bf16 v[168:171], v[120:123], v[92:95], v[168:171]
ds_read_b64_tr_b16 v[82:83], v4 offset:4160
v_mfma_f32_16x16x32_bf16 v[160:163], v[112:115], v[92:95], v[160:163]
ds_read_b128 v[44:47], v2 offset:30720
v_mfma_f32_16x16x32_bf16 v[164:167], v[116:119], v[92:95], v[164:167]
ds_read_b128 v[48:51], v2 offset:32768
v_mfma_f32_16x16x32_bf16 v[172:175], v[92:95], v[124:127], v[172:175]
ds_read_b128 v[52:55], v2 offset:34816
v_mfma_f32_16x16x32_bf16 v[184:187], v[120:123], v[96:99], v[184:187]
ds_read_b128 v[56:59], v2 offset:36864
v_mfma_f32_16x16x32_bf16 v[176:179], v[112:115], v[96:99], v[176:179]
ds_read_b128 v[60:63], v2 offset:38912
v_mfma_f32_16x16x32_bf16 v[180:183], v[116:119], v[96:99], v[180:183]
ds_read_b128 v[64:67], v2 offset:40960
v_mfma_f32_16x16x32_bf16 v[188:191], v[96:99], v[124:127], v[188:191]
v_add_u32_e64 v6, v6, v14
v_mfma_f32_16x16x32_bf16 v[200:203], v[120:123], v[100:103], v[200:203]
v_add_u32_e64 v7, v7, v14
v_mfma_f32_16x16x32_bf16 v[192:195], v[112:115], v[100:103], v[192:195]
v_mfma_f32_16x16x32_bf16 v[196:199], v[116:119], v[100:103], v[196:199]
v_mfma_f32_16x16x32_bf16 v[204:207], v[100:103], v[124:127], v[204:207]
v_mfma_f32_16x16x32_bf16 v[216:219], v[120:123], v[104:107], v[216:219]
v_mfma_f32_16x16x32_bf16 v[208:211], v[112:115], v[104:107], v[208:211]
v_mfma_f32_16x16x32_bf16 v[212:215], v[116:119], v[104:107], v[212:215]
v_mfma_f32_16x16x32_bf16 v[220:223], v[104:107], v[124:127], v[220:223]
v_mfma_f32_16x16x32_bf16 v[232:235], v[120:123], v[108:111], v[232:235]
v_mfma_f32_16x16x32_bf16 v[224:227], v[112:115], v[108:111], v[224:227]
v_mfma_f32_16x16x32_bf16 v[228:231], v[116:119], v[108:111], v[228:231]
v_mfma_f32_16x16x32_bf16 v[236:239], v[108:111], v[124:127], v[236:239]
s_waitcnt lgkmcnt(0)
s_barrier
v_mfma_f32_16x16x32_bf16 v[136:139], v[76:79], v[40:43], v[136:139]
ds_read_b128 v[84:87], v3 offset:28672
v_mfma_f32_16x16x32_bf16 v[128:131], v[68:71], v[40:43], v[128:131]
ds_read_b64_tr_b16 v[112:113], v4 offset:15360
v_mfma_f32_16x16x32_bf16 v[132:135], v[72:75], v[40:43], v[132:135]
ds_read_b64_tr_b16 v[114:115], v4 offset:19200
v_mfma_f32_16x16x32_bf16 v[140:143], v[40:43], v[80:83], v[140:143]
ds_read_b64_tr_b16 v[116:117], v4 offset:15520
v_mfma_f32_16x16x32_bf16 v[152:155], v[76:79], v[44:47], v[152:155]
ds_read_b64_tr_b16 v[118:119], v4 offset:19360
v_mfma_f32_16x16x32_bf16 v[144:147], v[68:71], v[44:47], v[144:147]
ds_read_b64_tr_b16 v[120:121], v6
v_mfma_f32_16x16x32_bf16 v[148:151], v[72:75], v[44:47], v[148:151]
ds_read_b64_tr_b16 v[122:123], v7
v_mfma_f32_16x16x32_bf16 v[156:159], v[44:47], v[80:83], v[156:159]
ds_read_b64_tr_b16 v[124:125], v4 offset:15680
v_mfma_f32_16x16x32_bf16 v[168:171], v[76:79], v[48:51], v[168:171]
ds_read_b64_tr_b16 v[126:127], v4 offset:19520
v_mfma_f32_16x16x32_bf16 v[160:163], v[68:71], v[48:51], v[160:163]
ds_read_b128 v[88:91], v3 offset:30720
v_mfma_f32_16x16x32_bf16 v[164:167], v[72:75], v[48:51], v[164:167]
ds_read_b128 v[92:95], v3 offset:32768
v_mfma_f32_16x16x32_bf16 v[172:175], v[48:51], v[80:83], v[172:175]
ds_read_b128 v[96:99], v3 offset:34816
v_mfma_f32_16x16x32_bf16 v[184:187], v[76:79], v[52:55], v[184:187]
ds_read_b128 v[100:103], v3 offset:36864
v_mfma_f32_16x16x32_bf16 v[176:179], v[68:71], v[52:55], v[176:179]
ds_read_b128 v[104:107], v3 offset:38912
v_mfma_f32_16x16x32_bf16 v[180:183], v[72:75], v[52:55], v[180:183]
ds_read_b128 v[108:111], v3 offset:40960
v_mfma_f32_16x16x32_bf16 v[188:191], v[52:55], v[80:83], v[188:191]
v_add_u32_e64 v6, v6, v14
v_mfma_f32_16x16x32_bf16 v[200:203], v[76:79], v[56:59], v[200:203]
v_add_u32_e64 v7, v7, v14
v_mfma_f32_16x16x32_bf16 v[192:195], v[68:71], v[56:59], v[192:195]
v_mfma_f32_16x16x32_bf16 v[196:199], v[72:75], v[56:59], v[196:199]
v_mfma_f32_16x16x32_bf16 v[204:207], v[56:59], v[80:83], v[204:207]
v_mfma_f32_16x16x32_bf16 v[216:219], v[76:79], v[60:63], v[216:219]
v_mfma_f32_16x16x32_bf16 v[208:211], v[68:71], v[60:63], v[208:211]
v_mfma_f32_16x16x32_bf16 v[212:215], v[72:75], v[60:63], v[212:215]
v_mfma_f32_16x16x32_bf16 v[220:223], v[60:63], v[80:83], v[220:223]
v_mfma_f32_16x16x32_bf16 v[232:235], v[76:79], v[64:67], v[232:235]
v_mfma_f32_16x16x32_bf16 v[224:227], v[68:71], v[64:67], v[224:227]
v_mfma_f32_16x16x32_bf16 v[228:231], v[72:75], v[64:67], v[228:231]
v_mfma_f32_16x16x32_bf16 v[236:239], v[64:67], v[80:83], v[236:239]
s_waitcnt lgkmcnt(0)
s_barrier
v_mfma_f32_16x16x32_bf16 v[136:139], v[120:123], v[84:87], v[136:139]
ds_read_b128 v[40:43], v2 offset:0
v_mfma_f32_16x16x32_bf16 v[128:131], v[112:115], v[84:87], v[128:131]
ds_read_b64_tr_b16 v[68:69], v4 offset:30720
v_mfma_f32_16x16x32_bf16 v[132:135], v[116:119], v[84:87], v[132:135]
ds_read_b64_tr_b16 v[70:71], v4 offset:34560
v_mfma_f32_16x16x32_bf16 v[140:143], v[84:87], v[124:127], v[140:143]
ds_read_b64_tr_b16 v[72:73], v4 offset:30880
v_mfma_f32_16x16x32_bf16 v[152:155], v[120:123], v[88:91], v[152:155]
ds_read_b64_tr_b16 v[74:75], v4 offset:34720
v_mfma_f32_16x16x32_bf16 v[144:147], v[112:115], v[88:91], v[144:147]
ds_read_b64_tr_b16 v[76:77], v6
v_mfma_f32_16x16x32_bf16 v[148:151], v[116:119], v[88:91], v[148:151]
ds_read_b64_tr_b16 v[78:79], v7
v_mfma_f32_16x16x32_bf16 v[156:159], v[88:91], v[124:127], v[156:159]
ds_read_b64_tr_b16 v[80:81], v4 offset:31040
v_mfma_f32_16x16x32_bf16 v[168:171], v[120:123], v[92:95], v[168:171]
ds_read_b64_tr_b16 v[82:83], v4 offset:34880
v_mfma_f32_16x16x32_bf16 v[160:163], v[112:115], v[92:95], v[160:163]
ds_read_b128 v[44:47], v2 offset:2048
v_mfma_f32_16x16x32_bf16 v[164:167], v[116:119], v[92:95], v[164:167]
ds_read_b128 v[48:51], v2 offset:4096
v_mfma_f32_16x16x32_bf16 v[172:175], v[92:95], v[124:127], v[172:175]
ds_read_b128 v[52:55], v2 offset:6144
v_mfma_f32_16x16x32_bf16 v[184:187], v[120:123], v[96:99], v[184:187]
ds_read_b128 v[56:59], v2 offset:8192
v_mfma_f32_16x16x32_bf16 v[176:179], v[112:115], v[96:99], v[176:179]
ds_read_b128 v[60:63], v2 offset:10240
v_mfma_f32_16x16x32_bf16 v[180:183], v[116:119], v[96:99], v[180:183]
ds_read_b128 v[64:67], v2 offset:12288
v_mfma_f32_16x16x32_bf16 v[188:191], v[96:99], v[124:127], v[188:191]
v_add_u32_e64 v6, v6, v14
v_mfma_f32_16x16x32_bf16 v[200:203], v[120:123], v[100:103], v[200:203]
v_add_u32_e64 v7, v7, v14
v_mfma_f32_16x16x32_bf16 v[192:195], v[112:115], v[100:103], v[192:195]
v_mfma_f32_16x16x32_bf16 v[196:199], v[116:119], v[100:103], v[196:199]
v_mfma_f32_16x16x32_bf16 v[204:207], v[100:103], v[124:127], v[204:207]
v_mfma_f32_16x16x32_bf16 v[216:219], v[120:123], v[104:107], v[216:219]
v_mfma_f32_16x16x32_bf16 v[208:211], v[112:115], v[104:107], v[208:211]
v_mfma_f32_16x16x32_bf16 v[212:215], v[116:119], v[104:107], v[212:215]
v_mfma_f32_16x16x32_bf16 v[220:223], v[104:107], v[124:127], v[220:223]
v_mfma_f32_16x16x32_bf16 v[232:235], v[120:123], v[108:111], v[232:235]
v_mfma_f32_16x16x32_bf16 v[224:227], v[112:115], v[108:111], v[224:227]
v_mfma_f32_16x16x32_bf16 v[228:231], v[116:119], v[108:111], v[228:231]
v_mfma_f32_16x16x32_bf16 v[236:239], v[108:111], v[124:127], v[236:239]
s_waitcnt lgkmcnt(0)
s_barrier
v_mfma_f32_16x16x32_bf16 v[136:139], v[76:79], v[40:43], v[136:139]
ds_read_b128 v[84:87], v3 offset:0
v_mfma_f32_16x16x32_bf16 v[128:131], v[68:71], v[40:43], v[128:131]
ds_read_b64_tr_b16 v[112:113], v5 offset:0
v_mfma_f32_16x16x32_bf16 v[132:135], v[72:75], v[40:43], v[132:135]
ds_read_b64_tr_b16 v[114:115], v5 offset:3840
v_mfma_f32_16x16x32_bf16 v[140:143], v[40:43], v[80:83], v[140:143]
ds_read_b64_tr_b16 v[116:117], v5 offset:160
v_mfma_f32_16x16x32_bf16 v[152:155], v[76:79], v[44:47], v[152:155]
ds_read_b64_tr_b16 v[118:119], v5 offset:4000
v_mfma_f32_16x16x32_bf16 v[144:147], v[68:71], v[44:47], v[144:147]
ds_read_b64_tr_b16 v[120:121], v6
v_mfma_f32_16x16x32_bf16 v[148:151], v[72:75], v[44:47], v[148:151]
ds_read_b64_tr_b16 v[122:123], v7
v_mfma_f32_16x16x32_bf16 v[156:159], v[44:47], v[80:83], v[156:159]
ds_read_b64_tr_b16 v[124:125], v5 offset:320
v_mfma_f32_16x16x32_bf16 v[168:171], v[76:79], v[48:51], v[168:171]
ds_read_b64_tr_b16 v[126:127], v5 offset:4160
v_mfma_f32_16x16x32_bf16 v[160:163], v[68:71], v[48:51], v[160:163]
ds_read_b128 v[88:91], v3 offset:2048
v_mfma_f32_16x16x32_bf16 v[164:167], v[72:75], v[48:51], v[164:167]
ds_read_b128 v[92:95], v3 offset:4096
v_mfma_f32_16x16x32_bf16 v[172:175], v[48:51], v[80:83], v[172:175]
ds_read_b128 v[96:99], v3 offset:6144
v_mfma_f32_16x16x32_bf16 v[184:187], v[76:79], v[52:55], v[184:187]
ds_read_b128 v[100:103], v3 offset:8192
v_mfma_f32_16x16x32_bf16 v[176:179], v[68:71], v[52:55], v[176:179]
ds_read_b128 v[104:107], v3 offset:10240
v_mfma_f32_16x16x32_bf16 v[180:183], v[72:75], v[52:55], v[180:183]
ds_read_b128 v[108:111], v3 offset:12288
v_mfma_f32_16x16x32_bf16 v[188:191], v[52:55], v[80:83], v[188:191]
v_add_u32_e64 v6, v6, v15
v_mfma_f32_16x16x32_bf16 v[200:203], v[76:79], v[56:59], v[200:203]
v_add_u32_e64 v7, v7, v15
v_mfma_f32_16x16x32_bf16 v[192:195], v[68:71], v[56:59], v[192:195]
v_mfma_f32_16x16x32_bf16 v[196:199], v[72:75], v[56:59], v[196:199]
v_mfma_f32_16x16x32_bf16 v[204:207], v[56:59], v[80:83], v[204:207]
v_mfma_f32_16x16x32_bf16 v[216:219], v[76:79], v[60:63], v[216:219]
v_mfma_f32_16x16x32_bf16 v[208:211], v[68:71], v[60:63], v[208:211]
v_mfma_f32_16x16x32_bf16 v[212:215], v[72:75], v[60:63], v[212:215]
v_mfma_f32_16x16x32_bf16 v[220:223], v[60:63], v[80:83], v[220:223]
v_mfma_f32_16x16x32_bf16 v[232:235], v[76:79], v[64:67], v[232:235]
v_mfma_f32_16x16x32_bf16 v[224:227], v[68:71], v[64:67], v[224:227]
v_mfma_f32_16x16x32_bf16 v[228:231], v[72:75], v[64:67], v[228:231]
v_mfma_f32_16x16x32_bf16 v[236:239], v[64:67], v[80:83], v[236:239]
s_waitcnt lgkmcnt(0)
s_barrier
v_mfma_f32_16x16x32_bf16 v[136:139], v[120:123], v[84:87], v[136:139]
ds_read_b128 v[40:43], v2 offset:14336
v_mfma_f32_16x16x32_bf16 v[128:131], v[112:115], v[84:87], v[128:131]
ds_read_b64_tr_b16 v[68:69], v4 offset:0
v_mfma_f32_16x16x32_bf16 v[132:135], v[116:119], v[84:87], v[132:135]
ds_read_b64_tr_b16 v[70:71], v4 offset:3840
v_mfma_f32_16x16x32_bf16 v[140:143], v[84:87], v[124:127], v[140:143]
ds_read_b64_tr_b16 v[72:73], v4 offset:160
v_mfma_f32_16x16x32_bf16 v[152:155], v[120:123], v[88:91], v[152:155]
ds_read_b64_tr_b16 v[74:75], v4 offset:4000
v_mfma_f32_16x16x32_bf16 v[144:147], v[112:115], v[88:91], v[144:147]
ds_read_b64_tr_b16 v[76:77], v6
v_mfma_f32_16x16x32_bf16 v[148:151], v[116:119], v[88:91], v[148:151]
ds_read_b64_tr_b16 v[78:79], v7
v_mfma_f32_16x16x32_bf16 v[156:159], v[88:91], v[124:127], v[156:159]
ds_read_b64_tr_b16 v[80:81], v4 offset:320
v_mfma_f32_16x16x32_bf16 v[168:171], v[120:123], v[92:95], v[168:171]
ds_read_b64_tr_b16 v[82:83], v4 offset:4160
v_mfma_f32_16x16x32_bf16 v[160:163], v[112:115], v[92:95], v[160:163]
ds_read_b128 v[44:47], v2 offset:16384
v_mfma_f32_16x16x32_bf16 v[164:167], v[116:119], v[92:95], v[164:167]
ds_read_b128 v[48:51], v2 offset:18432
v_mfma_f32_16x16x32_bf16 v[172:175], v[92:95], v[124:127], v[172:175]
ds_read_b128 v[52:55], v2 offset:20480
v_mfma_f32_16x16x32_bf16 v[184:187], v[120:123], v[96:99], v[184:187]
ds_read_b128 v[56:59], v2 offset:22528
v_mfma_f32_16x16x32_bf16 v[176:179], v[112:115], v[96:99], v[176:179]
ds_read_b128 v[60:63], v2 offset:24576
v_mfma_f32_16x16x32_bf16 v[180:183], v[116:119], v[96:99], v[180:183]
ds_read_b128 v[64:67], v2 offset:26624
v_mfma_f32_16x16x32_bf16 v[188:191], v[96:99], v[124:127], v[188:191]
v_add_u32_e64 v6, v6, v14
v_mfma_f32_16x16x32_bf16 v[200:203], v[120:123], v[100:103], v[200:203]
v_add_u32_e64 v7, v7, v14
v_mfma_f32_16x16x32_bf16 v[192:195], v[112:115], v[100:103], v[192:195]
v_mfma_f32_16x16x32_bf16 v[196:199], v[116:119], v[100:103], v[196:199]
v_mfma_f32_16x16x32_bf16 v[204:207], v[100:103], v[124:127], v[204:207]
v_mfma_f32_16x16x32_bf16 v[216:219], v[120:123], v[104:107], v[216:219]
v_mfma_f32_16x16x32_bf16 v[208:211], v[112:115], v[104:107], v[208:211]
v_mfma_f32_16x16x32_bf16 v[212:215], v[116:119], v[104:107], v[212:215]
v_mfma_f32_16x16x32_bf16 v[220:223], v[104:107], v[124:127], v[220:223]
v_mfma_f32_16x16x32_bf16 v[232:235], v[120:123], v[108:111], v[232:235]
v_mfma_f32_16x16x32_bf16 v[224:227], v[112:115], v[108:111], v[224:227]
v_mfma_f32_16x16x32_bf16 v[228:231], v[116:119], v[108:111], v[228:231]
v_mfma_f32_16x16x32_bf16 v[236:239], v[108:111], v[124:127], v[236:239]
s_waitcnt lgkmcnt(0)
s_barrier
v_mfma_f32_16x16x32_bf16 v[136:139], v[76:79], v[40:43], v[136:139]
ds_read_b128 v[84:87], v3 offset:14336
v_mfma_f32_16x16x32_bf16 v[128:131], v[68:71], v[40:43], v[128:131]
ds_read_b64_tr_b16 v[112:113], v4 offset:15360
v_mfma_f32_16x16x32_bf16 v[132:135], v[72:75], v[40:43], v[132:135]
ds_read_b64_tr_b16 v[114:115], v4 offset:19200
v_mfma_f32_16x16x32_bf16 v[140:143], v[40:43], v[80:83], v[140:143]
ds_read_b64_tr_b16 v[116:117], v4 offset:15520
v_mfma_f32_16x16x32_bf16 v[152:155], v[76:79], v[44:47], v[152:155]
ds_read_b64_tr_b16 v[118:119], v4 offset:19360
v_mfma_f32_16x16x32_bf16 v[144:147], v[68:71], v[44:47], v[144:147]
ds_read_b64_tr_b16 v[120:121], v6
v_mfma_f32_16x16x32_bf16 v[148:151], v[72:75], v[44:47], v[148:151]
ds_read_b64_tr_b16 v[122:123], v7
v_mfma_f32_16x16x32_bf16 v[156:159], v[44:47], v[80:83], v[156:159]
ds_read_b64_tr_b16 v[124:125], v4 offset:15680
v_mfma_f32_16x16x32_bf16 v[168:171], v[76:79], v[48:51], v[168:171]
ds_read_b64_tr_b16 v[126:127], v4 offset:19520
v_mfma_f32_16x16x32_bf16 v[160:163], v[68:71], v[48:51], v[160:163]
ds_read_b128 v[88:91], v3 offset:16384
v_mfma_f32_16x16x32_bf16 v[164:167], v[72:75], v[48:51], v[164:167]
ds_read_b128 v[92:95], v3 offset:18432
v_mfma_f32_16x16x32_bf16 v[172:175], v[48:51], v[80:83], v[172:175]
ds_read_b128 v[96:99], v3 offset:20480
v_mfma_f32_16x16x32_bf16 v[184:187], v[76:79], v[52:55], v[184:187]
ds_read_b128 v[100:103], v3 offset:22528
v_mfma_f32_16x16x32_bf16 v[176:179], v[68:71], v[52:55], v[176:179]
ds_read_b128 v[104:107], v3 offset:24576
v_mfma_f32_16x16x32_bf16 v[180:183], v[72:75], v[52:55], v[180:183]
ds_read_b128 v[108:111], v3 offset:26624
v_mfma_f32_16x16x32_bf16 v[188:191], v[52:55], v[80:83], v[188:191]
v_add_u32_e64 v6, v6, v14
v_mfma_f32_16x16x32_bf16 v[200:203], v[76:79], v[56:59], v[200:203]
v_add_u32_e64 v7, v7, v14
v_mfma_f32_16x16x32_bf16 v[192:195], v[68:71], v[56:59], v[192:195]
v_mfma_f32_16x16x32_bf16 v[196:199], v[72:75], v[56:59], v[196:199]
v_mfma_f32_16x16x32_bf16 v[204:207], v[56:59], v[80:83], v[204:207]
v_mfma_f32_16x16x32_bf16 v[216:219], v[76:79], v[60:63], v[216:219]
v_mfma_f32_16x16x32_bf16 v[208:211], v[68:71], v[60:63], v[208:211]
v_mfma_f32_16x16x32_bf16 v[212:215], v[72:75], v[60:63], v[212:215]
v_mfma_f32_16x16x32_bf16 v[220:223], v[60:63], v[80:83], v[220:223]
v_mfma_f32_16x16x32_bf16 v[232:235], v[76:79], v[64:67], v[232:235]
v_mfma_f32_16x16x32_bf16 v[224:227], v[68:71], v[64:67], v[224:227]
v_mfma_f32_16x16x32_bf16 v[228:231], v[72:75], v[64:67], v[228:231]
v_mfma_f32_16x16x32_bf16 v[236:239], v[64:67], v[80:83], v[236:239]
s_waitcnt lgkmcnt(0)
s_barrier
v_mfma_f32_16x16x32_bf16 v[136:139], v[120:123], v[84:87], v[136:139]
ds_read_b128 v[40:43], v2 offset:28672
v_mfma_f32_16x16x32_bf16 v[128:131], v[112:115], v[84:87], v[128:131]
ds_read_b64_tr_b16 v[68:69], v4 offset:30720
v_mfma_f32_16x16x32_bf16 v[132:135], v[116:119], v[84:87], v[132:135]
ds_read_b64_tr_b16 v[70:71], v4 offset:34560
v_mfma_f32_16x16x32_bf16 v[140:143], v[84:87], v[124:127], v[140:143]
ds_read_b64_tr_b16 v[72:73], v4 offset:30880
v_mfma_f32_16x16x32_bf16 v[152:155], v[120:123], v[88:91], v[152:155]
ds_read_b64_tr_b16 v[74:75], v4 offset:34720
v_mfma_f32_16x16x32_bf16 v[144:147], v[112:115], v[88:91], v[144:147]
ds_read_b64_tr_b16 v[76:77], v6
v_mfma_f32_16x16x32_bf16 v[148:151], v[116:119], v[88:91], v[148:151]
ds_read_b64_tr_b16 v[78:79], v7
v_mfma_f32_16x16x32_bf16 v[156:159], v[88:91], v[124:127], v[156:159]
ds_read_b64_tr_b16 v[80:81], v4 offset:31040
v_mfma_f32_16x16x32_bf16 v[168:171], v[120:123], v[92:95], v[168:171]
ds_read_b64_tr_b16 v[82:83], v4 offset:34880
v_mfma_f32_16x16x32_bf16 v[160:163], v[112:115], v[92:95], v[160:163]
ds_read_b128 v[44:47], v2 offset:30720
v_mfma_f32_16x16x32_bf16 v[164:167], v[116:119], v[92:95], v[164:167]
ds_read_b128 v[48:51], v2 offset:32768
v_mfma_f32_16x16x32_bf16 v[172:175], v[92:95], v[124:127], v[172:175]
ds_read_b128 v[52:55], v2 offset:34816
v_mfma_f32_16x16x32_bf16 v[184:187], v[120:123], v[96:99], v[184:187]
ds_read_b128 v[56:59], v2 offset:36864
v_mfma_f32_16x16x32_bf16 v[176:179], v[112:115], v[96:99], v[176:179]
ds_read_b128 v[60:63], v2 offset:38912
v_mfma_f32_16x16x32_bf16 v[180:183], v[116:119], v[96:99], v[180:183]
ds_read_b128 v[64:67], v2 offset:40960
v_mfma_f32_16x16x32_bf16 v[188:191], v[96:99], v[124:127], v[188:191]
v_add_u32_e64 v6, v6, v14
v_mfma_f32_16x16x32_bf16 v[200:203], v[120:123], v[100:103], v[200:203]
v_add_u32_e64 v7, v7, v14
v_mfma_f32_16x16x32_bf16 v[192:195], v[112:115], v[100:103], v[192:195]
v_mfma_f32_16x16x32_bf16 v[196:199], v[116:119], v[100:103], v[196:199]
v_mfma_f32_16x16x32_bf16 v[204:207], v[100:103], v[124:127], v[204:207]
v_mfma_f32_16x16x32_bf16 v[216:219], v[120:123], v[104:107], v[216:219]
v_mfma_f32_16x16x32_bf16 v[208:211], v[112:115], v[104:107], v[208:211]
v_mfma_f32_16x16x32_bf16 v[212:215], v[116:119], v[104:107], v[212:215]
v_mfma_f32_16x16x32_bf16 v[220:223], v[104:107], v[124:127], v[220:223]
v_mfma_f32_16x16x32_bf16 v[232:235], v[120:123], v[108:111], v[232:235]
v_mfma_f32_16x16x32_bf16 v[224:227], v[112:115], v[108:111], v[224:227]
v_mfma_f32_16x16x32_bf16 v[228:231], v[116:119], v[108:111], v[228:231]
v_mfma_f32_16x16x32_bf16 v[236:239], v[108:111], v[124:127], v[236:239]
s_waitcnt lgkmcnt(0)
s_barrier
v_mfma_f32_16x16x32_bf16 v[136:139], v[76:79], v[40:43], v[136:139]
ds_read_b128 v[84:87], v3 offset:28672
v_mfma_f32_16x16x32_bf16 v[128:131], v[68:71], v[40:43], v[128:131]
ds_read_b64_tr_b16 v[112:113], v5 offset:0
v_mfma_f32_16x16x32_bf16 v[132:135], v[72:75], v[40:43], v[132:135]
ds_read_b64_tr_b16 v[114:115], v5 offset:3840
v_mfma_f32_16x16x32_bf16 v[140:143], v[40:43], v[80:83], v[140:143]
ds_read_b64_tr_b16 v[116:117], v5 offset:160
v_mfma_f32_16x16x32_bf16 v[152:155], v[76:79], v[44:47], v[152:155]
ds_read_b64_tr_b16 v[118:119], v5 offset:4000
v_mfma_f32_16x16x32_bf16 v[144:147], v[68:71], v[44:47], v[144:147]
ds_read_b64_tr_b16 v[120:121], v6
v_mfma_f32_16x16x32_bf16 v[148:151], v[72:75], v[44:47], v[148:151]
ds_read_b64_tr_b16 v[122:123], v7
v_mfma_f32_16x16x32_bf16 v[156:159], v[44:47], v[80:83], v[156:159]
ds_read_b64_tr_b16 v[124:125], v5 offset:320
v_mfma_f32_16x16x32_bf16 v[168:171], v[76:79], v[48:51], v[168:171]
ds_read_b64_tr_b16 v[126:127], v5 offset:4160
v_mfma_f32_16x16x32_bf16 v[160:163], v[68:71], v[48:51], v[160:163]
ds_read_b128 v[88:91], v3 offset:30720
v_mfma_f32_16x16x32_bf16 v[164:167], v[72:75], v[48:51], v[164:167]
ds_read_b128 v[92:95], v3 offset:32768
v_mfma_f32_16x16x32_bf16 v[172:175], v[48:51], v[80:83], v[172:175]
ds_read_b128 v[96:99], v3 offset:34816
v_mfma_f32_16x16x32_bf16 v[184:187], v[76:79], v[52:55], v[184:187]
ds_read_b128 v[100:103], v3 offset:36864
v_mfma_f32_16x16x32_bf16 v[176:179], v[68:71], v[52:55], v[176:179]
ds_read_b128 v[104:107], v3 offset:38912
v_mfma_f32_16x16x32_bf16 v[180:183], v[72:75], v[52:55], v[180:183]
ds_read_b128 v[108:111], v3 offset:40960
v_mfma_f32_16x16x32_bf16 v[188:191], v[52:55], v[80:83], v[188:191]
v_add_u32_e64 v6, v6, v15
v_mfma_f32_16x16x32_bf16 v[200:203], v[76:79], v[56:59], v[200:203]
v_add_u32_e64 v7, v7, v15
v_mfma_f32_16x16x32_bf16 v[192:195], v[68:71], v[56:59], v[192:195]
v_mfma_f32_16x16x32_bf16 v[196:199], v[72:75], v[56:59], v[196:199]
v_mfma_f32_16x16x32_bf16 v[204:207], v[56:59], v[80:83], v[204:207]
v_mfma_f32_16x16x32_bf16 v[216:219], v[76:79], v[60:63], v[216:219]
v_mfma_f32_16x16x32_bf16 v[208:211], v[68:71], v[60:63], v[208:211]
v_mfma_f32_16x16x32_bf16 v[212:215], v[72:75], v[60:63], v[212:215]
v_mfma_f32_16x16x32_bf16 v[220:223], v[60:63], v[80:83], v[220:223]
v_mfma_f32_16x16x32_bf16 v[232:235], v[76:79], v[64:67], v[232:235]
v_mfma_f32_16x16x32_bf16 v[224:227], v[68:71], v[64:67], v[224:227]
v_mfma_f32_16x16x32_bf16 v[228:231], v[72:75], v[64:67], v[228:231]
v_mfma_f32_16x16x32_bf16 v[236:239], v[64:67], v[80:83], v[236:239]
s_waitcnt lgkmcnt(0)
s_barrier
v_mfma_f32_16x16x32_bf16 v[136:139], v[120:123], v[84:87], v[136:139]
ds_read_b128 v[40:43], v2 offset:0
v_mfma_f32_16x16x32_bf16 v[128:131], v[112:115], v[84:87], v[128:131]
ds_read_b64_tr_b16 v[68:69], v4 offset:0
v_mfma_f32_16x16x32_bf16 v[132:135], v[116:119], v[84:87], v[132:135]
ds_read_b64_tr_b16 v[70:71], v4 offset:3840
v_mfma_f32_16x16x32_bf16 v[140:143], v[84:87], v[124:127], v[140:143]
ds_read_b64_tr_b16 v[72:73], v4 offset:160
v_mfma_f32_16x16x32_bf16 v[152:155], v[120:123], v[88:91], v[152:155]
ds_read_b64_tr_b16 v[74:75], v4 offset:4000
v_mfma_f32_16x16x32_bf16 v[144:147], v[112:115], v[88:91], v[144:147]
ds_read_b64_tr_b16 v[76:77], v6
v_mfma_f32_16x16x32_bf16 v[148:151], v[116:119], v[88:91], v[148:151]
ds_read_b64_tr_b16 v[78:79], v7
v_mfma_f32_16x16x32_bf16 v[156:159], v[88:91], v[124:127], v[156:159]
ds_read_b64_tr_b16 v[80:81], v4 offset:320
v_mfma_f32_16x16x32_bf16 v[168:171], v[120:123], v[92:95], v[168:171]
ds_read_b64_tr_b16 v[82:83], v4 offset:4160
v_mfma_f32_16x16x32_bf16 v[160:163], v[112:115], v[92:95], v[160:163]
ds_read_b128 v[44:47], v2 offset:2048
v_mfma_f32_16x16x32_bf16 v[164:167], v[116:119], v[92:95], v[164:167]
ds_read_b128 v[48:51], v2 offset:4096
v_mfma_f32_16x16x32_bf16 v[172:175], v[92:95], v[124:127], v[172:175]
ds_read_b128 v[52:55], v2 offset:6144
v_mfma_f32_16x16x32_bf16 v[184:187], v[120:123], v[96:99], v[184:187]
ds_read_b128 v[56:59], v2 offset:8192
v_mfma_f32_16x16x32_bf16 v[176:179], v[112:115], v[96:99], v[176:179]
ds_read_b128 v[60:63], v2 offset:10240
v_mfma_f32_16x16x32_bf16 v[180:183], v[116:119], v[96:99], v[180:183]
ds_read_b128 v[64:67], v2 offset:12288
v_mfma_f32_16x16x32_bf16 v[188:191], v[96:99], v[124:127], v[188:191]
v_add_u32_e64 v6, v6, v14
v_mfma_f32_16x16x32_bf16 v[200:203], v[120:123], v[100:103], v[200:203]
v_add_u32_e64 v7, v7, v14
v_mfma_f32_16x16x32_bf16 v[192:195], v[112:115], v[100:103], v[192:195]
v_mfma_f32_16x16x32_bf16 v[196:199], v[116:119], v[100:103], v[196:199]
v_mfma_f32_16x16x32_bf16 v[204:207], v[100:103], v[124:127], v[204:207]
v_mfma_f32_16x16x32_bf16 v[216:219], v[120:123], v[104:107], v[216:219]
v_mfma_f32_16x16x32_bf16 v[208:211], v[112:115], v[104:107], v[208:211]
v_mfma_f32_16x16x32_bf16 v[212:215], v[116:119], v[104:107], v[212:215]
v_mfma_f32_16x16x32_bf16 v[220:223], v[104:107], v[124:127], v[220:223]
v_mfma_f32_16x16x32_bf16 v[232:235], v[120:123], v[108:111], v[232:235]
v_mfma_f32_16x16x32_bf16 v[224:227], v[112:115], v[108:111], v[224:227]
v_mfma_f32_16x16x32_bf16 v[228:231], v[116:119], v[108:111], v[228:231]
v_mfma_f32_16x16x32_bf16 v[236:239], v[108:111], v[124:127], v[236:239]
s_waitcnt lgkmcnt(0)
s_barrier
v_mfma_f32_16x16x32_bf16 v[136:139], v[76:79], v[40:43], v[136:139]
ds_read_b128 v[84:87], v3 offset:0
v_mfma_f32_16x16x32_bf16 v[128:131], v[68:71], v[40:43], v[128:131]
ds_read_b64_tr_b16 v[112:113], v4 offset:15360
v_mfma_f32_16x16x32_bf16 v[132:135], v[72:75], v[40:43], v[132:135]
ds_read_b64_tr_b16 v[114:115], v4 offset:19200
v_mfma_f32_16x16x32_bf16 v[140:143], v[40:43], v[80:83], v[140:143]
ds_read_b64_tr_b16 v[116:117], v4 offset:15520
v_mfma_f32_16x16x32_bf16 v[152:155], v[76:79], v[44:47], v[152:155]
ds_read_b64_tr_b16 v[118:119], v4 offset:19360
v_mfma_f32_16x16x32_bf16 v[144:147], v[68:71], v[44:47], v[144:147]
ds_read_b64_tr_b16 v[120:121], v6
v_mfma_f32_16x16x32_bf16 v[148:151], v[72:75], v[44:47], v[148:151]
ds_read_b64_tr_b16 v[122:123], v7
v_mfma_f32_16x16x32_bf16 v[156:159], v[44:47], v[80:83], v[156:159]
ds_read_b64_tr_b16 v[124:125], v4 offset:15680
v_mfma_f32_16x16x32_bf16 v[168:171], v[76:79], v[48:51], v[168:171]
ds_read_b64_tr_b16 v[126:127], v4 offset:19520
v_mfma_f32_16x16x32_bf16 v[160:163], v[68:71], v[48:51], v[160:163]
ds_read_b128 v[88:91], v3 offset:2048
v_mfma_f32_16x16x32_bf16 v[164:167], v[72:75], v[48:51], v[164:167]
ds_read_b128 v[92:95], v3 offset:4096
v_mfma_f32_16x16x32_bf16 v[172:175], v[48:51], v[80:83], v[172:175]
ds_read_b128 v[96:99], v3 offset:6144
v_mfma_f32_16x16x32_bf16 v[184:187], v[76:79], v[52:55], v[184:187]
ds_read_b128 v[100:103], v3 offset:8192
v_mfma_f32_16x16x32_bf16 v[176:179], v[68:71], v[52:55], v[176:179]
ds_read_b128 v[104:107], v3 offset:10240
v_mfma_f32_16x16x32_bf16 v[180:183], v[72:75], v[52:55], v[180:183]
ds_read_b128 v[108:111], v3 offset:12288
v_mfma_f32_16x16x32_bf16 v[188:191], v[52:55], v[80:83], v[188:191]
v_add_u32_e64 v6, v6, v14
v_mfma_f32_16x16x32_bf16 v[200:203], v[76:79], v[56:59], v[200:203]
v_add_u32_e64 v7, v7, v14
v_mfma_f32_16x16x32_bf16 v[192:195], v[68:71], v[56:59], v[192:195]
v_mfma_f32_16x16x32_bf16 v[196:199], v[72:75], v[56:59], v[196:199]
v_mfma_f32_16x16x32_bf16 v[204:207], v[56:59], v[80:83], v[204:207]
v_mfma_f32_16x16x32_bf16 v[216:219], v[76:79], v[60:63], v[216:219]
v_mfma_f32_16x16x32_bf16 v[208:211], v[68:71], v[60:63], v[208:211]
v_mfma_f32_16x16x32_bf16 v[212:215], v[72:75], v[60:63], v[212:215]
v_mfma_f32_16x16x32_bf16 v[220:223], v[60:63], v[80:83], v[220:223]
v_mfma_f32_16x16x32_bf16 v[232:235], v[76:79], v[64:67], v[232:235]
v_mfma_f32_16x16x32_bf16 v[224:227], v[68:71], v[64:67], v[224:227]
v_mfma_f32_16x16x32_bf16 v[228:231], v[72:75], v[64:67], v[228:231]
v_mfma_f32_16x16x32_bf16 v[236:239], v[64:67], v[80:83], v[236:239]
s_waitcnt lgkmcnt(0)
s_barrier
s_load_dwordx2 s[96:97], s[16:17], 0
v_mfma_f32_16x16x32_bf16 v[136:139], v[120:123], v[84:87], v[136:139]
ds_read_b128 v[40:43], v2 offset:14336
v_mfma_f32_16x16x32_bf16 v[128:131], v[112:115], v[84:87], v[128:131]
ds_read_b64_tr_b16 v[68:69], v4 offset:30720
v_mfma_f32_16x16x32_bf16 v[132:135], v[116:119], v[84:87], v[132:135]
ds_read_b64_tr_b16 v[70:71], v4 offset:34560
v_mfma_f32_16x16x32_bf16 v[140:143], v[84:87], v[124:127], v[140:143]
ds_read_b64_tr_b16 v[72:73], v4 offset:30880
v_mfma_f32_16x16x32_bf16 v[152:155], v[120:123], v[88:91], v[152:155]
ds_read_b64_tr_b16 v[74:75], v4 offset:34720
v_mfma_f32_16x16x32_bf16 v[144:147], v[112:115], v[88:91], v[144:147]
ds_read_b64_tr_b16 v[76:77], v6
v_mfma_f32_16x16x32_bf16 v[148:151], v[116:119], v[88:91], v[148:151]
ds_read_b64_tr_b16 v[78:79], v7
v_mfma_f32_16x16x32_bf16 v[156:159], v[88:91], v[124:127], v[156:159]
ds_read_b64_tr_b16 v[80:81], v4 offset:31040
v_mfma_f32_16x16x32_bf16 v[168:171], v[120:123], v[92:95], v[168:171]
ds_read_b64_tr_b16 v[82:83], v4 offset:34880
v_mfma_f32_16x16x32_bf16 v[160:163], v[112:115], v[92:95], v[160:163]
ds_read_b128 v[44:47], v2 offset:16384
v_mfma_f32_16x16x32_bf16 v[164:167], v[116:119], v[92:95], v[164:167]
ds_read_b128 v[48:51], v2 offset:18432
v_mfma_f32_16x16x32_bf16 v[172:175], v[92:95], v[124:127], v[172:175]
ds_read_b128 v[52:55], v2 offset:20480
v_mfma_f32_16x16x32_bf16 v[184:187], v[120:123], v[96:99], v[184:187]
ds_read_b128 v[56:59], v2 offset:22528
v_mfma_f32_16x16x32_bf16 v[176:179], v[112:115], v[96:99], v[176:179]
ds_read_b128 v[60:63], v2 offset:24576
v_mfma_f32_16x16x32_bf16 v[180:183], v[116:119], v[96:99], v[180:183]
ds_read_b128 v[64:67], v2 offset:26624
v_mfma_f32_16x16x32_bf16 v[188:191], v[96:99], v[124:127], v[188:191]
v_add_u32_e64 v6, v6, v14
v_mfma_f32_16x16x32_bf16 v[200:203], v[120:123], v[100:103], v[200:203]
v_add_u32_e64 v7, v7, v14
v_mfma_f32_16x16x32_bf16 v[192:195], v[112:115], v[100:103], v[192:195]
v_mfma_f32_16x16x32_bf16 v[196:199], v[116:119], v[100:103], v[196:199]
v_mfma_f32_16x16x32_bf16 v[204:207], v[100:103], v[124:127], v[204:207]
v_mfma_f32_16x16x32_bf16 v[216:219], v[120:123], v[104:107], v[216:219]
v_mfma_f32_16x16x32_bf16 v[208:211], v[112:115], v[104:107], v[208:211]
v_mfma_f32_16x16x32_bf16 v[212:215], v[116:119], v[104:107], v[212:215]
v_mfma_f32_16x16x32_bf16 v[220:223], v[104:107], v[124:127], v[220:223]
v_mfma_f32_16x16x32_bf16 v[232:235], v[120:123], v[108:111], v[232:235]
v_mfma_f32_16x16x32_bf16 v[224:227], v[112:115], v[108:111], v[224:227]
v_mfma_f32_16x16x32_bf16 v[228:231], v[116:119], v[108:111], v[228:231]
v_mfma_f32_16x16x32_bf16 v[236:239], v[108:111], v[124:127], v[236:239]
s_waitcnt lgkmcnt(0)
s_barrier
v_mfma_f32_16x16x32_bf16 v[136:139], v[76:79], v[40:43], v[136:139]
ds_read_b128 v[84:87], v3 offset:14336
v_mfma_f32_16x16x32_bf16 v[128:131], v[68:71], v[40:43], v[128:131]
ds_read_b64_tr_b16 v[112:113], v5 offset:0
v_mfma_f32_16x16x32_bf16 v[132:135], v[72:75], v[40:43], v[132:135]
ds_read_b64_tr_b16 v[114:115], v5 offset:3840
v_mfma_f32_16x16x32_bf16 v[140:143], v[40:43], v[80:83], v[140:143]
ds_read_b64_tr_b16 v[116:117], v5 offset:160
v_mfma_f32_16x16x32_bf16 v[152:155], v[76:79], v[44:47], v[152:155]
ds_read_b64_tr_b16 v[118:119], v5 offset:4000
v_mfma_f32_16x16x32_bf16 v[144:147], v[68:71], v[44:47], v[144:147]
ds_read_b64_tr_b16 v[120:121], v6
v_mfma_f32_16x16x32_bf16 v[148:151], v[72:75], v[44:47], v[148:151]
ds_read_b64_tr_b16 v[122:123], v7
v_mfma_f32_16x16x32_bf16 v[156:159], v[44:47], v[80:83], v[156:159]
ds_read_b64_tr_b16 v[124:125], v5 offset:320
v_mfma_f32_16x16x32_bf16 v[168:171], v[76:79], v[48:51], v[168:171]
ds_read_b64_tr_b16 v[126:127], v5 offset:4160
v_mfma_f32_16x16x32_bf16 v[160:163], v[68:71], v[48:51], v[160:163]
ds_read_b128 v[88:91], v3 offset:16384
v_mfma_f32_16x16x32_bf16 v[164:167], v[72:75], v[48:51], v[164:167]
ds_read_b128 v[92:95], v3 offset:18432
v_mfma_f32_16x16x32_bf16 v[172:175], v[48:51], v[80:83], v[172:175]
ds_read_b128 v[96:99], v3 offset:20480
v_mfma_f32_16x16x32_bf16 v[184:187], v[76:79], v[52:55], v[184:187]
ds_read_b128 v[100:103], v3 offset:22528
v_mfma_f32_16x16x32_bf16 v[176:179], v[68:71], v[52:55], v[176:179]
ds_read_b128 v[104:107], v3 offset:24576
v_mfma_f32_16x16x32_bf16 v[180:183], v[72:75], v[52:55], v[180:183]
ds_read_b128 v[108:111], v3 offset:26624
v_mfma_f32_16x16x32_bf16 v[188:191], v[52:55], v[80:83], v[188:191]
v_add_u32_e64 v6, v6, v15
v_mfma_f32_16x16x32_bf16 v[200:203], v[76:79], v[56:59], v[200:203]
v_add_u32_e64 v7, v7, v15
v_mfma_f32_16x16x32_bf16 v[192:195], v[68:71], v[56:59], v[192:195]
v_mfma_f32_16x16x32_bf16 v[196:199], v[72:75], v[56:59], v[196:199]
v_mfma_f32_16x16x32_bf16 v[204:207], v[56:59], v[80:83], v[204:207]
v_mfma_f32_16x16x32_bf16 v[216:219], v[76:79], v[60:63], v[216:219]
v_mfma_f32_16x16x32_bf16 v[208:211], v[68:71], v[60:63], v[208:211]
v_mfma_f32_16x16x32_bf16 v[212:215], v[72:75], v[60:63], v[212:215]
v_mfma_f32_16x16x32_bf16 v[220:223], v[60:63], v[80:83], v[220:223]
v_mfma_f32_16x16x32_bf16 v[232:235], v[76:79], v[64:67], v[232:235]
v_mfma_f32_16x16x32_bf16 v[224:227], v[68:71], v[64:67], v[224:227]
v_mfma_f32_16x16x32_bf16 v[228:231], v[72:75], v[64:67], v[228:231]
v_mfma_f32_16x16x32_bf16 v[236:239], v[64:67], v[80:83], v[236:239]
s_waitcnt lgkmcnt(0)
s_barrier
v_mfma_f32_16x16x32_bf16 v[136:139], v[120:123], v[84:87], v[136:139]
ds_read_b128 v[40:43], v2 offset:28672
v_mfma_f32_16x16x32_bf16 v[128:131], v[112:115], v[84:87], v[128:131]
ds_read_b64_tr_b16 v[68:69], v4 offset:0
v_mfma_f32_16x16x32_bf16 v[132:135], v[116:119], v[84:87], v[132:135]
ds_read_b64_tr_b16 v[70:71], v4 offset:3840
v_mfma_f32_16x16x32_bf16 v[140:143], v[84:87], v[124:127], v[140:143]
ds_read_b64_tr_b16 v[72:73], v4 offset:160
v_mfma_f32_16x16x32_bf16 v[152:155], v[120:123], v[88:91], v[152:155]
ds_read_b64_tr_b16 v[74:75], v4 offset:4000
v_mfma_f32_16x16x32_bf16 v[144:147], v[112:115], v[88:91], v[144:147]
ds_read_b64_tr_b16 v[76:77], v6
v_mfma_f32_16x16x32_bf16 v[148:151], v[116:119], v[88:91], v[148:151]
ds_read_b64_tr_b16 v[78:79], v7
v_mfma_f32_16x16x32_bf16 v[156:159], v[88:91], v[124:127], v[156:159]
ds_read_b64_tr_b16 v[80:81], v4 offset:320
v_mfma_f32_16x16x32_bf16 v[168:171], v[120:123], v[92:95], v[168:171]
ds_read_b64_tr_b16 v[82:83], v4 offset:4160
v_mfma_f32_16x16x32_bf16 v[160:163], v[112:115], v[92:95], v[160:163]
ds_read_b128 v[44:47], v2 offset:30720
v_mfma_f32_16x16x32_bf16 v[164:167], v[116:119], v[92:95], v[164:167]
ds_read_b128 v[48:51], v2 offset:32768
v_mfma_f32_16x16x32_bf16 v[172:175], v[92:95], v[124:127], v[172:175]
ds_read_b128 v[52:55], v2 offset:34816
v_mfma_f32_16x16x32_bf16 v[184:187], v[120:123], v[96:99], v[184:187]
ds_read_b128 v[56:59], v2 offset:36864
v_mfma_f32_16x16x32_bf16 v[176:179], v[112:115], v[96:99], v[176:179]
ds_read_b128 v[60:63], v2 offset:38912
v_mfma_f32_16x16x32_bf16 v[180:183], v[116:119], v[96:99], v[180:183]
ds_read_b128 v[64:67], v2 offset:40960
v_mfma_f32_16x16x32_bf16 v[188:191], v[96:99], v[124:127], v[188:191]
v_add_u32_e64 v6, v6, v14
v_mfma_f32_16x16x32_bf16 v[200:203], v[120:123], v[100:103], v[200:203]
v_add_u32_e64 v7, v7, v14
v_mfma_f32_16x16x32_bf16 v[192:195], v[112:115], v[100:103], v[192:195]
v_mfma_f32_16x16x32_bf16 v[196:199], v[116:119], v[100:103], v[196:199]
v_mfma_f32_16x16x32_bf16 v[204:207], v[100:103], v[124:127], v[204:207]
v_mfma_f32_16x16x32_bf16 v[216:219], v[120:123], v[104:107], v[216:219]
v_mfma_f32_16x16x32_bf16 v[208:211], v[112:115], v[104:107], v[208:211]
v_mfma_f32_16x16x32_bf16 v[212:215], v[116:119], v[104:107], v[212:215]
v_mfma_f32_16x16x32_bf16 v[220:223], v[104:107], v[124:127], v[220:223]
v_mfma_f32_16x16x32_bf16 v[232:235], v[120:123], v[108:111], v[232:235]
v_mfma_f32_16x16x32_bf16 v[224:227], v[112:115], v[108:111], v[224:227]
v_mfma_f32_16x16x32_bf16 v[228:231], v[116:119], v[108:111], v[228:231]
v_mfma_f32_16x16x32_bf16 v[236:239], v[108:111], v[124:127], v[236:239]
s_waitcnt lgkmcnt(0)
s_barrier
v_mfma_f32_16x16x32_bf16 v[136:139], v[76:79], v[40:43], v[136:139]
ds_read_b128 v[84:87], v3 offset:28672
v_mfma_f32_16x16x32_bf16 v[128:131], v[68:71], v[40:43], v[128:131]
ds_read_b64_tr_b16 v[112:113], v4 offset:15360
v_mfma_f32_16x16x32_bf16 v[132:135], v[72:75], v[40:43], v[132:135]
ds_read_b64_tr_b16 v[114:115], v4 offset:19200
v_mfma_f32_16x16x32_bf16 v[140:143], v[40:43], v[80:83], v[140:143]
ds_read_b64_tr_b16 v[116:117], v4 offset:15520
v_mfma_f32_16x16x32_bf16 v[152:155], v[76:79], v[44:47], v[152:155]
ds_read_b64_tr_b16 v[118:119], v4 offset:19360
v_mfma_f32_16x16x32_bf16 v[144:147], v[68:71], v[44:47], v[144:147]
ds_read_b64_tr_b16 v[120:121], v6
v_mfma_f32_16x16x32_bf16 v[148:151], v[72:75], v[44:47], v[148:151]
ds_read_b64_tr_b16 v[122:123], v7
v_mfma_f32_16x16x32_bf16 v[156:159], v[44:47], v[80:83], v[156:159]
ds_read_b64_tr_b16 v[124:125], v4 offset:15680
v_mfma_f32_16x16x32_bf16 v[168:171], v[76:79], v[48:51], v[168:171]
ds_read_b64_tr_b16 v[126:127], v4 offset:19520
v_mfma_f32_16x16x32_bf16 v[160:163], v[68:71], v[48:51], v[160:163]
ds_read_b128 v[88:91], v3 offset:30720
v_mfma_f32_16x16x32_bf16 v[164:167], v[72:75], v[48:51], v[164:167]
ds_read_b128 v[92:95], v3 offset:32768
v_mfma_f32_16x16x32_bf16 v[172:175], v[48:51], v[80:83], v[172:175]
ds_read_b128 v[96:99], v3 offset:34816
v_mfma_f32_16x16x32_bf16 v[184:187], v[76:79], v[52:55], v[184:187]
ds_read_b128 v[100:103], v3 offset:36864
v_mfma_f32_16x16x32_bf16 v[176:179], v[68:71], v[52:55], v[176:179]
ds_read_b128 v[104:107], v3 offset:38912
v_mfma_f32_16x16x32_bf16 v[180:183], v[72:75], v[52:55], v[180:183]
ds_read_b128 v[108:111], v3 offset:40960
v_mfma_f32_16x16x32_bf16 v[188:191], v[52:55], v[80:83], v[188:191]
v_add_u32_e64 v6, v6, v14
v_mfma_f32_16x16x32_bf16 v[200:203], v[76:79], v[56:59], v[200:203]
v_add_u32_e64 v7, v7, v14
v_mfma_f32_16x16x32_bf16 v[192:195], v[68:71], v[56:59], v[192:195]
v_mfma_f32_16x16x32_bf16 v[196:199], v[72:75], v[56:59], v[196:199]
v_mfma_f32_16x16x32_bf16 v[204:207], v[56:59], v[80:83], v[204:207]
v_mfma_f32_16x16x32_bf16 v[216:219], v[76:79], v[60:63], v[216:219]
v_mfma_f32_16x16x32_bf16 v[208:211], v[68:71], v[60:63], v[208:211]
v_mfma_f32_16x16x32_bf16 v[212:215], v[72:75], v[60:63], v[212:215]
v_mfma_f32_16x16x32_bf16 v[220:223], v[60:63], v[80:83], v[220:223]
v_mfma_f32_16x16x32_bf16 v[232:235], v[76:79], v[64:67], v[232:235]
v_mfma_f32_16x16x32_bf16 v[224:227], v[68:71], v[64:67], v[224:227]
v_mfma_f32_16x16x32_bf16 v[228:231], v[72:75], v[64:67], v[228:231]
v_mfma_f32_16x16x32_bf16 v[236:239], v[64:67], v[80:83], v[236:239]
s_waitcnt lgkmcnt(0)
s_barrier
v_mfma_f32_16x16x32_bf16 v[136:139], v[120:123], v[84:87], v[136:139]
ds_read_b128 v[40:43], v2 offset:0
v_mfma_f32_16x16x32_bf16 v[128:131], v[112:115], v[84:87], v[128:131]
ds_read_b64_tr_b16 v[68:69], v4 offset:30720
v_mfma_f32_16x16x32_bf16 v[132:135], v[116:119], v[84:87], v[132:135]
ds_read_b64_tr_b16 v[70:71], v4 offset:34560
v_mfma_f32_16x16x32_bf16 v[140:143], v[84:87], v[124:127], v[140:143]
ds_read_b64_tr_b16 v[72:73], v4 offset:30880
v_mfma_f32_16x16x32_bf16 v[152:155], v[120:123], v[88:91], v[152:155]
ds_read_b64_tr_b16 v[74:75], v4 offset:34720
v_mfma_f32_16x16x32_bf16 v[144:147], v[112:115], v[88:91], v[144:147]
ds_read_b64_tr_b16 v[76:77], v6
v_mfma_f32_16x16x32_bf16 v[148:151], v[116:119], v[88:91], v[148:151]
ds_read_b64_tr_b16 v[78:79], v7
v_mfma_f32_16x16x32_bf16 v[156:159], v[88:91], v[124:127], v[156:159]
ds_read_b64_tr_b16 v[80:81], v4 offset:31040
v_mfma_f32_16x16x32_bf16 v[168:171], v[120:123], v[92:95], v[168:171]
ds_read_b64_tr_b16 v[82:83], v4 offset:34880
v_mfma_f32_16x16x32_bf16 v[160:163], v[112:115], v[92:95], v[160:163]
ds_read_b128 v[44:47], v2 offset:2048
v_mfma_f32_16x16x32_bf16 v[164:167], v[116:119], v[92:95], v[164:167]
ds_read_b128 v[48:51], v2 offset:4096
v_mfma_f32_16x16x32_bf16 v[172:175], v[92:95], v[124:127], v[172:175]
ds_read_b128 v[52:55], v2 offset:6144
v_mfma_f32_16x16x32_bf16 v[184:187], v[120:123], v[96:99], v[184:187]
ds_read_b128 v[56:59], v2 offset:8192
v_mfma_f32_16x16x32_bf16 v[176:179], v[112:115], v[96:99], v[176:179]
ds_read_b128 v[60:63], v2 offset:10240
v_mfma_f32_16x16x32_bf16 v[180:183], v[116:119], v[96:99], v[180:183]
ds_read_b128 v[64:67], v2 offset:12288
v_mfma_f32_16x16x32_bf16 v[188:191], v[96:99], v[124:127], v[188:191]
v_add_u32_e64 v6, v6, v14
v_mfma_f32_16x16x32_bf16 v[200:203], v[120:123], v[100:103], v[200:203]
v_add_u32_e64 v7, v7, v14
v_mfma_f32_16x16x32_bf16 v[192:195], v[112:115], v[100:103], v[192:195]
v_mfma_f32_16x16x32_bf16 v[196:199], v[116:119], v[100:103], v[196:199]
v_mfma_f32_16x16x32_bf16 v[204:207], v[100:103], v[124:127], v[204:207]
v_mfma_f32_16x16x32_bf16 v[216:219], v[120:123], v[104:107], v[216:219]
v_mfma_f32_16x16x32_bf16 v[208:211], v[112:115], v[104:107], v[208:211]
v_mfma_f32_16x16x32_bf16 v[212:215], v[116:119], v[104:107], v[212:215]
v_mfma_f32_16x16x32_bf16 v[220:223], v[104:107], v[124:127], v[220:223]
v_mfma_f32_16x16x32_bf16 v[232:235], v[120:123], v[108:111], v[232:235]
v_mfma_f32_16x16x32_bf16 v[224:227], v[112:115], v[108:111], v[224:227]
v_mfma_f32_16x16x32_bf16 v[228:231], v[116:119], v[108:111], v[228:231]
v_mfma_f32_16x16x32_bf16 v[236:239], v[108:111], v[124:127], v[236:239]
s_waitcnt lgkmcnt(0)
s_barrier
v_mfma_f32_16x16x32_bf16 v[136:139], v[76:79], v[40:43], v[136:139]
ds_read_b128 v[84:87], v3 offset:0
ds_read_b64_tr_b16 v[112:113], v5 offset:0
v_mfma_f32_16x16x32_bf16 v[128:131], v[68:71], v[40:43], v[128:131]
ds_read_b64_tr_b16 v[114:115], v5 offset:3840
ds_read_b64_tr_b16 v[116:117], v5 offset:160
v_mfma_f32_16x16x32_bf16 v[132:135], v[72:75], v[40:43], v[132:135]
ds_read_b64_tr_b16 v[118:119], v5 offset:4000
ds_read_b64_tr_b16 v[120:121], v6
v_mfma_f32_16x16x32_bf16 v[140:143], v[40:43], v[80:83], v[140:143]
ds_read_b64_tr_b16 v[122:123], v7
ds_read_b64_tr_b16 v[124:125], v5 offset:320
v_mfma_f32_16x16x32_bf16 v[152:155], v[76:79], v[44:47], v[152:155]
ds_read_b64_tr_b16 v[126:127], v5 offset:4160
ds_read_b128 v[88:91], v3 offset:2048
v_mfma_f32_16x16x32_bf16 v[144:147], v[68:71], v[44:47], v[144:147]
ds_read_b128 v[92:95], v3 offset:4096
ds_read_b128 v[96:99], v3 offset:6144
v_mfma_f32_16x16x32_bf16 v[148:151], v[72:75], v[44:47], v[148:151]
ds_read_b128 v[100:103], v3 offset:8192
ds_read_b128 v[104:107], v3 offset:10240
v_mfma_f32_16x16x32_bf16 v[156:159], v[44:47], v[80:83], v[156:159]
ds_read_b128 v[108:111], v3 offset:12288
v_mfma_f32_16x16x32_bf16 v[168:171], v[76:79], v[48:51], v[168:171]
v_mfma_f32_16x16x32_bf16 v[160:163], v[68:71], v[48:51], v[160:163]
v_mfma_f32_16x16x32_bf16 v[164:167], v[72:75], v[48:51], v[164:167]
v_mfma_f32_16x16x32_bf16 v[172:175], v[48:51], v[80:83], v[172:175]
v_mfma_f32_16x16x32_bf16 v[184:187], v[76:79], v[52:55], v[184:187]
v_mfma_f32_16x16x32_bf16 v[176:179], v[68:71], v[52:55], v[176:179]
v_mfma_f32_16x16x32_bf16 v[180:183], v[72:75], v[52:55], v[180:183]
v_mfma_f32_16x16x32_bf16 v[188:191], v[52:55], v[80:83], v[188:191]
s_waitcnt lgkmcnt(0)
s_barrier
v_mfma_f32_16x16x32_bf16 v[136:139], v[120:123], v[84:87], v[136:139]
v_mfma_f32_16x16x32_bf16 v[128:131], v[112:115], v[84:87], v[128:131]
v_mfma_f32_16x16x32_bf16 v[132:135], v[116:119], v[84:87], v[132:135]
v_mfma_f32_16x16x32_bf16 v[140:143], v[84:87], v[124:127], v[140:143]
v_mfma_f32_16x16x32_bf16 v[200:203], v[76:79], v[56:59], v[200:203]
v_mfma_f32_16x16x32_bf16 v[192:195], v[68:71], v[56:59], v[192:195]
s_nop 2
v_cvt_pk_bf16_f32 v136, v136, v137
v_cvt_pk_bf16_f32 v137, v138, v139
v_mfma_f32_16x16x32_bf16 v[196:199], v[72:75], v[56:59], v[196:199]
ds_write_b64 v8, v[136:137] offset:0
v_mfma_f32_16x16x32_bf16 v[204:207], v[56:59], v[80:83], v[204:207]
v_cvt_pk_bf16_f32 v128, v128, v129
v_cvt_pk_bf16_f32 v129, v130, v131
v_mfma_f32_16x16x32_bf16 v[152:155], v[120:123], v[88:91], v[152:155]
v_cvt_pk_bf16_f32 v132, v132, v133
v_cvt_pk_bf16_f32 v133, v134, v135
v_mfma_f32_16x16x32_bf16 v[144:147], v[112:115], v[88:91], v[144:147]
ds_read_b64 v[134:135], v13 offset:0
v_mul_f64 v[130:131], v[136:137], v[36:37]
v_mfma_f32_16x16x32_bf16 v[148:151], v[116:119], v[88:91], v[148:151]
ds_read_b64_tr_b16 v[42:43], v9 offset:0
v_cvt_pk_bf16_f32 v86, v140, v141
v_mfma_f32_16x16x32_bf16 v[156:159], v[88:91], v[124:127], v[156:159]
v_cvt_pk_bf16_f32 v87, v142, v143
v_mfma_f32_16x16x32_bf16 v[216:219], v[76:79], v[60:63], v[216:219]
v_mfma_f32_16x16x32_bf16 v[208:211], v[68:71], v[60:63], v[208:211]
v_cvt_pk_bf16_f32 v152, v152, v153
v_cvt_pk_bf16_f32 v153, v154, v155
v_mfma_f32_16x16x32_bf16 v[212:215], v[72:75], v[60:63], v[212:215]
ds_write_b64 v8, v[152:153] offset:512
v_mfma_f32_16x16x32_bf16 v[220:223], v[60:63], v[80:83], v[220:223]
v_cvt_pk_bf16_f32 v144, v144, v145
v_cvt_pk_bf16_f32 v145, v146, v147
v_mfma_f32_16x16x32_bf16 v[168:171], v[120:123], v[92:95], v[168:171]
v_cvt_pk_bf16_f32 v148, v148, v149
v_cvt_pk_bf16_f32 v149, v150, v151
v_mfma_f32_16x16x32_bf16 v[160:163], v[112:115], v[92:95], v[160:163]
ds_read_b64 v[150:151], v13 offset:512
v_mul_f64 v[146:147], v[152:153], v[36:37]
v_mfma_f32_16x16x32_bf16 v[164:167], v[116:119], v[92:95], v[164:167]
ds_read_b64_tr_b16 v[44:45], v9 offset:512
v_cvt_pk_bf16_f32 v88, v156, v157
v_mfma_f32_16x16x32_bf16 v[172:175], v[92:95], v[124:127], v[172:175]
v_cvt_pk_bf16_f32 v89, v158, v159
v_mfma_f32_16x16x32_bf16 v[232:235], v[76:79], v[64:67], v[232:235]
v_mfma_f32_16x16x32_bf16 v[224:227], v[68:71], v[64:67], v[224:227]
v_cvt_pk_bf16_f32 v168, v168, v169
v_cvt_pk_bf16_f32 v169, v170, v171
v_mfma_f32_16x16x32_bf16 v[228:231], v[72:75], v[64:67], v[228:231]
ds_write_b64 v8, v[168:169] offset:1024
v_mfma_f32_16x16x32_bf16 v[236:239], v[64:67], v[80:83], v[236:239]
v_cvt_pk_bf16_f32 v160, v160, v161
v_cvt_pk_bf16_f32 v161, v162, v163
v_mfma_f32_16x16x32_bf16 v[184:187], v[120:123], v[96:99], v[184:187]
v_cvt_pk_bf16_f32 v164, v164, v165
v_cvt_pk_bf16_f32 v165, v166, v167
v_mfma_f32_16x16x32_bf16 v[176:179], v[112:115], v[96:99], v[176:179]
ds_read_b64 v[166:167], v13 offset:1024
v_mul_f64 v[162:163], v[168:169], v[36:37]
v_mfma_f32_16x16x32_bf16 v[180:183], v[116:119], v[96:99], v[180:183]
ds_read_b64_tr_b16 v[46:47], v9 offset:1024
v_cvt_pk_bf16_f32 v90, v172, v173
v_mfma_f32_16x16x32_bf16 v[188:191], v[96:99], v[124:127], v[188:191]
v_cvt_pk_bf16_f32 v91, v174, v175
v_mfma_f32_16x16x32_bf16 v[200:203], v[120:123], v[100:103], v[200:203]
v_mfma_f32_16x16x32_bf16 v[192:195], v[112:115], v[100:103], v[192:195]
v_cvt_pk_bf16_f32 v184, v184, v185
v_cvt_pk_bf16_f32 v185, v186, v187
v_mfma_f32_16x16x32_bf16 v[196:199], v[116:119], v[100:103], v[196:199]
ds_write_b64 v8, v[184:185] offset:1536
v_mfma_f32_16x16x32_bf16 v[204:207], v[100:103], v[124:127], v[204:207]
v_cvt_pk_bf16_f32 v176, v176, v177
v_cvt_pk_bf16_f32 v177, v178, v179
v_mfma_f32_16x16x32_bf16 v[216:219], v[120:123], v[104:107], v[216:219]
v_cvt_pk_bf16_f32 v180, v180, v181
v_cvt_pk_bf16_f32 v181, v182, v183
v_mfma_f32_16x16x32_bf16 v[208:211], v[112:115], v[104:107], v[208:211]
ds_read_b64 v[182:183], v13 offset:1536
v_mul_f64 v[178:179], v[184:185], v[36:37]
v_mfma_f32_16x16x32_bf16 v[212:215], v[116:119], v[104:107], v[212:215]
ds_read_b64_tr_b16 v[48:49], v9 offset:1536
v_cvt_pk_bf16_f32 v92, v188, v189
v_mfma_f32_16x16x32_bf16 v[220:223], v[104:107], v[124:127], v[220:223]
v_cvt_pk_bf16_f32 v93, v190, v191
v_cvt_pk_bf16_f32 v200, v200, v201
v_mfma_f32_16x16x32_bf16 v[232:235], v[120:123], v[108:111], v[232:235]
v_cvt_pk_bf16_f32 v201, v202, v203
ds_write_b64 v8, v[200:201] offset:2048
v_mfma_f32_16x16x32_bf16 v[224:227], v[112:115], v[108:111], v[224:227]
v_cvt_pk_bf16_f32 v192, v192, v193
v_cvt_pk_bf16_f32 v193, v194, v195
v_mfma_f32_16x16x32_bf16 v[228:231], v[116:119], v[108:111], v[228:231]
v_cvt_pk_bf16_f32 v196, v196, v197
v_cvt_pk_bf16_f32 v197, v198, v199
v_mfma_f32_16x16x32_bf16 v[236:239], v[108:111], v[124:127], v[236:239]
ds_read_b64 v[198:199], v13 offset:2048
v_mul_f64 v[194:195], v[200:201], v[36:37]
ds_read_b64_tr_b16 v[50:51], v9 offset:2048
v_cvt_pk_bf16_f32 v94, v204, v205
v_cvt_pk_bf16_f32 v95, v206, v207
s_waitcnt lgkmcnt(3)
v_mfma_f32_16x16x32_bf16 v[136:139], v[132:135], v[128:131], v[16:19]
v_cvt_pk_bf16_f32 v216, v216, v217
v_cvt_pk_bf16_f32 v217, v218, v219
v_mfma_f32_16x16x32_bf16 v[152:155], v[148:151], v[144:147], v[16:19]
ds_write_b64 v8, v[216:217] offset:2560
v_cvt_pk_bf16_f32 v208, v208, v209
v_mfma_f32_16x16x32_bf16 v[156:159], v[132:135], v[144:147], v[20:23]
v_cvt_pk_bf16_f32 v209, v210, v211
v_cvt_pk_bf16_f32 v212, v212, v213
v_mfma_f32_16x16x32_bf16 v[168:171], v[164:167], v[160:163], v[16:19]
v_cvt_pk_bf16_f32 v213, v214, v215
ds_read_b64 v[214:215], v13 offset:2560
v_mfma_f32_16x16x32_bf16 v[172:175], v[148:151], v[160:163], v[20:23]
v_mul_f64 v[210:211], v[216:217], v[36:37]
ds_read_b64_tr_b16 v[52:53], v9 offset:2560
v_mfma_f32_16x16x32_bf16 v[184:187], v[180:183], v[176:179], v[16:19]
v_cvt_pk_bf16_f32 v96, v220, v221
v_cvt_pk_bf16_f32 v97, v222, v223
v_mfma_f32_16x16x32_bf16 v[188:191], v[164:167], v[176:179], v[20:23]
v_max3_f32 v240, v136, v137, v138
v_max_f32 v240, v240, v139
v_max_f64 v[152:153], v[152:153], v[156:157]
v_max_f64 v[154:155], v[154:155], v[158:159]
v_max3_f32 v242, v152, v153, v154
v_max_f32 v242, v242, v155
s_waitcnt lgkmcnt(3)
v_mfma_f32_16x16x32_bf16 v[200:203], v[196:199], v[192:195], v[16:19]
v_max_f64 v[168:169], v[168:169], v[172:173]
v_max_f64 v[170:171], v[170:171], v[174:175]
v_max3_f32 v244, v168, v169, v170
v_mfma_f32_16x16x32_bf16 v[204:207], v[180:183], v[192:195], v[20:23]
v_max_f32 v244, v244, v171
v_max_f64 v[184:185], v[184:185], v[188:189]
v_max_f64 v[186:187], v[186:187], v[190:191]
v_max3_f32 v246, v184, v185, v186
v_max_f32 v246, v246, v187
v_cvt_pk_bf16_f32 v232, v232, v233
v_cvt_pk_bf16_f32 v233, v234, v235
v_permlane16_swap_b32 v240, v242
v_permlane16_swap_b32 v244, v246
v_max_f32 v240, v240, v242
v_max_f32 v244, v244, v246
ds_write_b64 v8, v[232:233] offset:3072
v_cvt_pk_bf16_f32 v224, v224, v225
v_permlane32_swap_b32 v240, v244
v_max_f32 v240, v240, v244
v_mul_f32 v244, s34, v240
v_mul_f32 v240, s34, v240
v_cvt_pk_bf16_f32 v225, v226, v227
v_cvt_pk_bf16_f32 v228, v228, v229
v_permlane32_swap_b32 v240, v244
v_mov_b32 v242, v240
v_mov_b32 v246, v244
v_cvt_pk_bf16_f32 v229, v230, v231
v_permlane16_swap_b32 v240, v242
v_permlane16_swap_b32 v244, v246
ds_read_b64 v[230:231], v13 offset:3072
v_mul_f64 v[226:227], v[232:233], v[36:37]
ds_read_b64_tr_b16 v[54:55], v9 offset:3072
v_cvt_pk_bf16_f32 v98, v236, v237
v_cvt_pk_bf16_f32 v99, v238, v239
v_mov_b64 v[84:85], 0
v_mov_b64 v[40:41], 0
v_pk_fma_f32 v[136:137], v[136:137], s[32:33], v[240:241] op_sel_hi:[1,1,0]
v_pk_fma_f32 v[138:139], v[138:139], s[32:33], v[240:241] op_sel_hi:[1,1,0]
v_pk_fma_f32 v[152:153], v[152:153], s[32:33], v[242:243] op_sel_hi:[1,1,0]
v_pk_fma_f32 v[154:155], v[154:155], s[32:33], v[242:243] op_sel_hi:[1,1,0]
v_pk_fma_f32 v[168:169], v[168:169], s[32:33], v[244:245] op_sel_hi:[1,1,0]
v_pk_fma_f32 v[170:171], v[170:171], s[32:33], v[244:245] op_sel_hi:[1,1,0]
v_pk_fma_f32 v[184:185], v[184:185], s[32:33], v[246:247] op_sel_hi:[1,1,0]
v_pk_fma_f32 v[186:187], v[186:187], s[32:33], v[246:247] op_sel_hi:[1,1,0]
s_waitcnt lgkmcnt(0)
v_exp_f32 v136, v136
v_mfma_f32_16x16x32_bf16 v[216:219], v[212:215], v[208:211], v[16:19]
v_exp_f32 v137, v137
v_mfma_f32_16x16x32_bf16 v[220:223], v[196:199], v[208:211], v[20:23]
v_exp_f32 v138, v138
v_mfma_f32_16x16x32_bf16 v[232:235], v[228:231], v[224:227], v[16:19]
v_exp_f32 v139, v139
v_mfma_f32_16x16x32_bf16 v[236:239], v[212:215], v[224:227], v[20:23]
v_cvt_pk_bf16_f32 v240, v136, v137
v_cvt_pk_bf16_f32 v241, v138, v139
v_mul_f64 v[128:129], v[240:241], v[24:25]
v_mul_f64 v[130:131], v[240:241], v[26:27]
v_exp_f32 v152, v152
v_exp_f32 v153, v153
v_mfma_f32_16x16x32_bf16 v[132:135], v[32:35], v[128:131], 0
v_exp_f32 v154, v154
v_mfma_f32_16x16x32_bf16 v[136:139], v[84:87], v[128:131], 0
v_exp_f32 v155, v155
v_mfma_f32_16x16x32_bf16 v[140:143], v[40:43], v[128:131], 0
v_cvt_pk_bf16_f32 v242, v152, v153
v_cvt_pk_bf16_f32 v243, v154, v155
v_mul_f64 v[144:145], v[242:243], v[24:25]
v_mul_f64 v[146:147], v[242:243], v[26:27]
v_exp_f32 v168, v168
v_exp_f32 v169, v169
v_mfma_f32_16x16x32_bf16 v[148:151], v[32:35], v[144:147], 0
v_exp_f32 v170, v170
v_mfma_f32_16x16x32_bf16 v[152:155], v[86:89], v[144:147], 0
v_exp_f32 v171, v171
v_mfma_f32_16x16x32_bf16 v[156:159], v[42:45], v[144:147], 0
v_cvt_pk_bf16_f32 v244, v168, v169
v_cvt_pk_bf16_f32 v245, v170, v171
v_mul_f64 v[160:161], v[244:245], v[24:25]
v_mul_f64 v[162:163], v[244:245], v[26:27]
v_exp_f32 v184, v184
v_exp_f32 v185, v185
v_mfma_f32_16x16x32_bf16 v[164:167], v[32:35], v[160:163], 0
v_exp_f32 v186, v186
v_mfma_f32_16x16x32_bf16 v[168:171], v[88:91], v[160:163], 0
v_exp_f32 v187, v187
v_mfma_f32_16x16x32_bf16 v[172:175], v[44:47], v[160:163], 0
v_cvt_pk_bf16_f32 v246, v184, v185
v_cvt_pk_bf16_f32 v247, v186, v187
v_mul_f64 v[176:177], v[246:247], v[24:25]
v_mul_f64 v[178:179], v[246:247], v[26:27]
v_rcp_f32 v240, v132
v_rcp_f32 v242, v148
v_mfma_f32_16x16x32_bf16 v[180:183], v[32:35], v[176:179], 0
v_max_f64 v[200:201], v[200:201], v[204:205]
v_max_f64 v[202:203], v[202:203], v[206:207]
v_mfma_f32_16x16x32_bf16 v[184:187], v[90:93], v[176:179], 0
v_max3_f32 v248, v200, v201, v202
v_max_f32 v248, v248, v203
v_mfma_f32_16x16x32_bf16 v[188:191], v[46:49], v[176:179], 0
v_rcp_f32 v244, v164
v_max_f64 v[216:217], v[216:217], v[220:221]
v_max_f64 v[218:219], v[218:219], v[222:223]
v_max3_f32 v250, v216, v217, v218
v_max_f32 v250, v250, v219
v_pk_mul_f32 v[136:137], v[136:137], v[240:241] op_sel_hi:[1,0]
v_pk_mul_f32 v[138:139], v[138:139], v[240:241] op_sel_hi:[1,0]
v_cvt_pk_bf16_f32 v128, v136, v137
v_cvt_pk_bf16_f32 v129, v138, v139
ds_write_b64 v10, v[128:129] offset:0
v_mul_f32_dpp v64, v140, v240 quad_perm:[0,1,2,3] row_mask:0x1 bank_mask:0xf
v_mul_f32_dpp v65, v141, v240 quad_perm:[0,1,2,3] row_mask:0x1 bank_mask:0xf
v_mul_f32_dpp v66, v142, v240 quad_perm:[0,1,2,3] row_mask:0x1 bank_mask:0xf
v_mul_f32_dpp v67, v143, v240 quad_perm:[0,1,2,3] row_mask:0x1 bank_mask:0xf
v_rcp_f32 v246, v180
v_max_f64 v[232:233], v[232:233], v[236:237]
v_max_f64 v[234:235], v[234:235], v[238:239]
v_max3_f32 v252, v232, v233, v234
v_max_f32 v252, v252, v235
v_mov_b32 v254, v252
v_pk_mul_f32 v[152:153], v[152:153], v[242:243] op_sel_hi:[1,0]
v_pk_mul_f32 v[154:155], v[154:155], v[242:243] op_sel_hi:[1,0]
v_cvt_pk_bf16_f32 v144, v152, v153
v_cvt_pk_bf16_f32 v145, v154, v155
ds_write_b64 v10, v[144:145] offset:1440
v_mul_f32_dpp v64, v156, v242 quad_perm:[0,1,2,3] row_mask:0x2 bank_mask:0xf
v_mul_f32_dpp v65, v157, v242 quad_perm:[0,1,2,3] row_mask:0x2 bank_mask:0xf
v_mul_f32_dpp v66, v158, v242 quad_perm:[0,1,2,3] row_mask:0x2 bank_mask:0xf
v_mul_f32_dpp v67, v159, v242 quad_perm:[0,1,2,3] row_mask:0x2 bank_mask:0xf
v_pk_mul_f32 v[168:169], v[168:169], v[244:245] op_sel_hi:[1,0]
v_pk_mul_f32 v[170:171], v[170:171], v[244:245] op_sel_hi:[1,0]
v_cvt_pk_bf16_f32 v160, v168, v169
v_cvt_pk_bf16_f32 v161, v170, v171
ds_write_b64 v10, v[160:161] offset:2880
v_mul_f32_dpp v64, v172, v244 quad_perm:[0,1,2,3] row_mask:0x4 bank_mask:0xf
v_mul_f32_dpp v65, v173, v244 quad_perm:[0,1,2,3] row_mask:0x4 bank_mask:0xf
v_mul_f32_dpp v66, v174, v244 quad_perm:[0,1,2,3] row_mask:0x4 bank_mask:0xf
v_mul_f32_dpp v67, v175, v244 quad_perm:[0,1,2,3] row_mask:0x4 bank_mask:0xf
v_permlane16_swap_b32 v248, v250
v_permlane16_swap_b32 v252, v254
v_max_f32 v248, v248, v250
v_max_f32 v252, v252, v254
v_pk_mul_f32 v[184:185], v[184:185], v[246:247] op_sel_hi:[1,0]
v_pk_mul_f32 v[186:187], v[186:187], v[246:247] op_sel_hi:[1,0]
v_permlane32_swap_b32 v248, v252
v_max_f32 v248, v248, v252
v_mul_f32 v252, s34, v248
v_mul_f32 v248, s34, v248
v_cvt_pk_bf16_f32 v176, v184, v185
v_cvt_pk_bf16_f32 v177, v186, v187
v_permlane32_swap_b32 v248, v252
v_mov_b32 v250, v248
v_mov_b32 v254, v252
ds_write_b64 v10, v[176:177] offset:4320
v_permlane16_swap_b32 v248, v250
v_permlane16_swap_b32 v252, v254
v_mul_f32_dpp v64, v188, v246 quad_perm:[0,1,2,3] row_mask:0x8 bank_mask:0xf
v_mul_f32_dpp v65, v189, v246 quad_perm:[0,1,2,3] row_mask:0x8 bank_mask:0xf
v_mul_f32_dpp v66, v190, v246 quad_perm:[0,1,2,3] row_mask:0x8 bank_mask:0xf
v_mul_f32_dpp v67, v191, v246 quad_perm:[0,1,2,3] row_mask:0x8 bank_mask:0xf
v_cvt_pk_bf16_f32 v64, v64, v65
v_cvt_pk_bf16_f32 v65, v66, v67
ds_write_b64 v11, v[64:65] offset:0
v_pk_fma_f32 v[200:201], v[200:201], s[32:33], v[248:249] op_sel_hi:[1,1,0]
v_pk_fma_f32 v[202:203], v[202:203], s[32:33], v[248:249] op_sel_hi:[1,1,0]
v_pk_fma_f32 v[216:217], v[216:217], s[32:33], v[250:251] op_sel_hi:[1,1,0]
v_pk_fma_f32 v[218:219], v[218:219], s[32:33], v[250:251] op_sel_hi:[1,1,0]
v_pk_fma_f32 v[232:233], v[232:233], s[32:33], v[252:253] op_sel_hi:[1,1,0]
v_pk_fma_f32 v[234:235], v[234:235], s[32:33], v[252:253] op_sel_hi:[1,1,0]
v_exp_f32 v200, v200
v_exp_f32 v201, v201
v_exp_f32 v202, v202
v_exp_f32 v203, v203
v_cvt_pk_bf16_f32 v248, v200, v201
v_cvt_pk_bf16_f32 v249, v202, v203
v_mul_f64 v[192:193], v[248:249], v[24:25]
v_mul_f64 v[194:195], v[248:249], v[26:27]
ds_write_b32 v38, v38
v_exp_f32 v216, v216
v_exp_f32 v217, v217
v_mfma_f32_16x16x32_bf16 v[196:199], v[32:35], v[192:195], 0
v_exp_f32 v218, v218
v_mfma_f32_16x16x32_bf16 v[200:203], v[92:95], v[192:195], 0
v_exp_f32 v219, v219
v_mfma_f32_16x16x32_bf16 v[204:207], v[48:51], v[192:195], 0
v_cvt_pk_bf16_f32 v250, v216, v217
v_cvt_pk_bf16_f32 v251, v218, v219
v_mul_f64 v[208:209], v[250:251], v[24:25]
v_mul_f64 v[210:211], v[250:251], v[26:27]
v_exp_f32 v232, v232
v_exp_f32 v233, v233
v_mfma_f32_16x16x32_bf16 v[212:215], v[32:35], v[208:211], 0
v_exp_f32 v234, v234
v_mfma_f32_16x16x32_bf16 v[216:219], v[94:97], v[208:211], 0
v_exp_f32 v235, v235
v_mfma_f32_16x16x32_bf16 v[220:223], v[50:53], v[208:211], 0
v_cvt_pk_bf16_f32 v252, v232, v233
v_cvt_pk_bf16_f32 v253, v234, v235
v_mul_f64 v[224:225], v[252:253], v[24:25]
v_mul_f64 v[226:227], v[252:253], v[26:27]
L_xa:
v_rcp_f32 v248, v196
s_nop 0
v_mfma_f32_16x16x32_bf16 v[228:231], v[32:35], v[224:227], 0
v_rcp_f32 v250, v212
v_mfma_f32_16x16x32_bf16 v[232:235], v[96:99], v[224:227], 0
v_mfma_f32_16x16x32_bf16 v[236:239], v[52:55], v[224:227], 0
v_pk_mul_f32 v[200:201], v[200:201], v[248:249] op_sel_hi:[1,0]
v_pk_mul_f32 v[202:203], v[202:203], v[248:249] op_sel_hi:[1,0]
v_cvt_pk_bf16_f32 v192, v200, v201
v_cvt_pk_bf16_f32 v193, v202, v203
ds_write_b64 v10, v[192:193] offset:5760
v_mul_f32_dpp v68, v204, v248 quad_perm:[0,1,2,3] row_mask:0x1 bank_mask:0xf
v_mul_f32_dpp v69, v205, v248 quad_perm:[0,1,2,3] row_mask:0x1 bank_mask:0xf
v_mul_f32_dpp v70, v206, v248 quad_perm:[0,1,2,3] row_mask:0x1 bank_mask:0xf
v_mul_f32_dpp v71, v207, v248 quad_perm:[0,1,2,3] row_mask:0x1 bank_mask:0xf
v_rcp_f32 v252, v228
v_pk_mul_f32 v[216:217], v[216:217], v[250:251] op_sel_hi:[1,0]
v_pk_mul_f32 v[218:219], v[218:219], v[250:251] op_sel_hi:[1,0]
v_cvt_pk_bf16_f32 v208, v216, v217
v_cvt_pk_bf16_f32 v209, v218, v219
ds_write_b64 v10, v[208:209] offset:7200
v_mul_f32_dpp v68, v220, v250 quad_perm:[0,1,2,3] row_mask:0x2 bank_mask:0xf
v_mul_f32_dpp v69, v221, v250 quad_perm:[0,1,2,3] row_mask:0x2 bank_mask:0xf
v_mul_f32_dpp v70, v222, v250 quad_perm:[0,1,2,3] row_mask:0x2 bank_mask:0xf
v_mul_f32_dpp v71, v223, v250 quad_perm:[0,1,2,3] row_mask:0x2 bank_mask:0xf
v_pk_mul_f32 v[232:233], v[232:233], v[252:253] op_sel_hi:[1,0]
v_pk_mul_f32 v[234:235], v[234:235], v[252:253] op_sel_hi:[1,0]
v_cvt_pk_bf16_f32 v224, v232, v233
v_cvt_pk_bf16_f32 v225, v234, v235
ds_write_b64 v10, v[224:225] offset:8640
v_mul_f32_dpp v68, v236, v252 quad_perm:[0,1,2,3] row_mask:0xc bank_mask:0xf
v_mul_f32_dpp v69, v237, v252 quad_perm:[0,1,2,3] row_mask:0xc bank_mask:0xf
v_mul_f32_dpp v70, v238, v252 quad_perm:[0,1,2,3] row_mask:0xc bank_mask:0xf
v_mul_f32_dpp v71, v239, v252 quad_perm:[0,1,2,3] row_mask:0xc bank_mask:0xf
v_cvt_pk_bf16_f32 v68, v68, v69
v_cvt_pk_bf16_f32 v69, v70, v71
s_mov_b32 exec_hi, 0xffff
ds_write_b64 v11, v[68:69] offset:5760
s_mov_b32 exec_hi, -1
s_waitcnt lgkmcnt(0)
s_barrier
s_waitcnt lgkmcnt(0)
s_cmp_lg_u32 s96, 0
s_cbranch_scc1 L_tg6
s_movk_i32 s59, 30000
v_mov_b32 v4, 0
L_th6:
s_sleep 8
buffer_load_dwordx2 v[2:3], v4, s[16:19], 0 offen sc1
s_waitcnt vmcnt(0)
v_readfirstlane_b32 s96, v2
v_readfirstlane_b32 s97, v3
s_sub_u32 s59, s59, 1
s_cbranch_scc1 L_tg6
s_cmp_eq_u32 s96, 0
s_cbranch_scc1 L_th6
s_nop 1
L_tg6:
v_and_b32 v13, 15, v0
v_lshrrev_b32 v14, 4, v0
s_mov_b32 s53, 0
s_lshl_b32 s28, s20, 9
s_add_u32 s28, s28, s85
v_lshl_add_u32 v3, v13, 5, s28
v_cvt_f32_u32 v4, v3
v_mul_f32 v4, 0x3a000000, v4
v_and_b32 v5, 2, v14
v_add_u32 v14, v14, v5
v_lshlrev_b32 v5, 2, v14
v_cvt_f32_u32 v5, v5
v_mul_f32 v5, v4, v5
v_cos_f32 v7, v5
v_sin_f32 v6, v5
v_add_f32 v5, v5, v4
v_cvt_pk_bf16_f32 v240, -v7, v6
v_cos_f32 v7, v5
v_sin_f32 v6, v5
v_add_f32 v5, v5, v4
v_cvt_pk_bf16_f32 v241, -v7, v6
v_cos_f32 v7, v5
v_sin_f32 v6, v5
v_add_f32 v5, v5, v4
v_cvt_pk_bf16_f32 v242, -v7, v6
v_cos_f32 v7, v5
v_sin_f32 v6, v5
v_fmac_f32 v5, 0x40a00000, v4
v_cvt_pk_bf16_f32 v243, -v7, v6
v_cos_f32 v7, v5
v_sin_f32 v6, v5
v_add_f32 v5, v5, v4
v_cvt_pk_bf16_f32 v244, -v7, v6
v_cos_f32 v7, v5
v_sin_f32 v6, v5
v_add_f32 v5, v5, v4
v_cvt_pk_bf16_f32 v245, -v7, v6
v_cos_f32 v7, v5
v_sin_f32 v6, v5
v_add_f32 v5, v5, v4
v_cvt_pk_bf16_f32 v246, -v7, v6
v_cos_f32 v7, v5
v_sin_f32 v6, v5
s_nop 0
v_cvt_pk_bf16_f32 v247, -v7, v6
v_lshlrev_b32 v6, 31, v0
v_xor_b32 v6, 0xbf80bf80, v6
v_cmp_gt_u32 vcc, 16, v0
s_cmp_ge_u32 s84, 4
s_cselect_b32 s30, 0x55555555, 0
v_cndmask_b32 v240, v240, v6, vcc
s_or_b32 s30, s30, 0x88888888
s_mov_b32 s31, s30
s_mov_b32 s28, 102400
v_and_b32 v6, 3, v0
v_mul_u32_u24 v6, 2576, v6
v_mul_u32_u24 v7, 320, v14
v_add3_u32 v6, v6, v7, s28
v_and_b32 v7, 12, v0
v_sub_u32 v8, 76, v7
v_cndmask_b32 v7, v7, v8, s[30:31]
v_add_u32 v248, v6, v7
v_cndmask_b32 v7, 16, -16, s[30:31]
v_add_u32 v249, v248, v7
v_add_u32 v250, v249, v7
v_add_u32 v251, v250, v7
v_add_u32 v252, v251, v7
v_lshrrev_b32 v14, 4, v0
v_cndmask_b32 v255, 1.0, -1.0, s[30:31]
s_cmp_eq_u32 s85, 0
s_cselect_b32 s28, 0xffff0000, -1
s_and_b32 s30, s30, s28
v_cndmask_b32 v254, 1.0, -1.0, s[30:31]
v_mov_b32 v24, 112800
s_movk_i32 s59, 2
v_lshl_add_u32 v15, s20, 2, v24
L_2_e0:
ds_read_b32 v25, v24
s_sub_u32 s59, s59, 1
s_cbranch_scc1 L_2_e1
s_waitcnt lgkmcnt(0)
v_cmp_eq_u32 vcc, 0, v25
s_cbranch_vccnz L_2_e0
ds_read2_b32 v[120:121], v248 offset0:0 offset1:20
ds_read2_b32 v[122:123], v248 offset0:40 offset1:60
ds_read2_b32 v[124:125], v248 offset0:160 offset1:180
ds_read2_b32 v[126:127], v248 offset0:200 offset1:220
ds_read2_b32 v[128:129], v249 offset0:0 offset1:20
ds_read2_b32 v[130:131], v249 offset0:40 offset1:60
ds_read2_b32 v[132:133], v249 offset0:160 offset1:180
ds_read2_b32 v[134:135], v249 offset0:200 offset1:220
ds_read2_b32 v[136:137], v250 offset0:0 offset1:20
ds_read2_b32 v[138:139], v250 offset0:40 offset1:60
ds_read2_b32 v[140:141], v250 offset0:160 offset1:180
ds_read2_b32 v[142:143], v250 offset0:200 offset1:220
ds_read2_b32 v[144:145], v251 offset0:0 offset1:20
ds_read2_b32 v[146:147], v251 offset0:40 offset1:60
ds_read2_b32 v[148:149], v251 offset0:160 offset1:180
ds_read2_b32 v[150:151], v251 offset0:200 offset1:220
ds_read2_b32 v[152:153], v252 offset0:0 offset1:20
ds_read2_b32 v[154:155], v252 offset0:40 offset1:60
ds_read2_b32 v[156:157], v252 offset0:160 offset1:180
ds_read2_b32 v[158:159], v252 offset0:200 offset1:220
s_mov_b32 s53, 1
L_2_e1:
ds_write_b32 v15, v15 offset:16
v_lshlrev_b32 v26, 4, v0
v_add_u32 v27, 51200, v26
s_mul_i32 s28, s20, 2816
s_add_u32 s28, s28, 112896
v_mul_u32_u24 v6, 176, v13
v_lshl_add_u32 v6, v14, 3, v6
v_add_u32 v29, s28, v6
v_add_u32 v6, 0, v0
v_mul_u32_u24 v7, 6554, v6
v_lshrrev_b32 v7, 16, v7
v_add_u32 v8, v6, v7
v_lshl_add_u32 v30, v8, 4, s28
v_mul_u32_u24 v7, 40800, v7
v_lshl_add_u32 v33, v6, 4, v7
v_add_u32 v6, 64, v0
v_mul_u32_u24 v7, 6554, v6
v_lshrrev_b32 v7, 16, v7
v_add_u32 v8, v6, v7
v_lshl_add_u32 v31, v8, 4, s28
v_mul_u32_u24 v7, 40800, v7
v_lshl_add_u32 v34, v6, 4, v7
v_add_u32 v6, 128, v0
v_mul_u32_u24 v7, 6554, v6
v_lshrrev_b32 v7, 16, v7
v_add_u32 v8, v6, v7
v_lshl_add_u32 v32, v8, 4, s28
v_mul_u32_u24 v7, 40800, v7
v_lshl_add_u32 v35, v6, 4, v7
s_lshl_b32 s45, s20, 9
s_add_u32 s45, s45, s85
s_mul_i32 s45, s45, 1280
s_mul_i32 s30, s84, 160
s_add_u32 s45, s45, s30
s_mul_i32 s44, s85, 81920
s_mul_i32 s30, s20, 20480
s_add_u32 s44, s44, s30
s_add_u32 s44, s44, 0
s_lshl_b32 s46, s85, 2
s_add_u32 s46, s46, s20
s_lshl_b32 s46, s46, 6
s_add_u32 s46, s46, 2621440
s_lshl_b32 s47, s21, 14
s_add_u32 s47, s47, 5242880
v_lshlrev_b32 v3, 2, v13
v_lshlrev_b32 v4, 7, v0
v_lshrrev_b32 v6, 5, v0
v_lshlrev_b32 v6, 9, v6
v_lshl_add_u32 v6, v13, 5, v6
v_and_b32 v7, 16, v0
v_add_u32 v2, v6, v7
v_mov_b32 v24, 112800
s_mov_b32 s51, s44
s_movk_i32 s52, 30000
s_cmp_eq_u32 s53, 0
s_cbranch_scc1 L_2_e2
s_waitcnt lgkmcnt(13)
v_pk_mul_f32 v[120:121], v[120:121], v[254:255]
v_pk_mul_f32 v[122:123], v[122:123], v[254:255] op_sel:[0,1]
v_pk_mul_f32 v[124:125], v[124:125], v[254:255] op_sel:[0,1]
v_pk_mul_f32 v[126:127], v[126:127], v[254:255] op_sel:[0,1]
s_waitcnt lgkmcnt(13)
v_pk_mul_f32 v[128:129], v[128:129], v[254:255]
v_pk_mul_f32 v[130:131], v[130:131], v[254:255] op_sel:[0,1]
v_pk_mul_f32 v[132:133], v[132:133], v[254:255] op_sel:[0,1]
v_pk_mul_f32 v[134:135], v[134:135], v[254:255] op_sel:[0,1]
s_waitcnt lgkmcnt(9)
v_pk_mul_f32 v[136:137], v[136:137], v[254:255]
v_pk_mul_f32 v[138:139], v[138:139], v[254:255] op_sel:[0,1]
v_pk_mul_f32 v[140:141], v[140:141], v[254:255] op_sel:[0,1]
v_pk_mul_f32 v[142:143], v[142:143], v[254:255] op_sel:[0,1]
s_waitcnt lgkmcnt(5)
v_pk_mul_f32 v[144:145], v[144:145], v[254:255]
v_pk_mul_f32 v[146:147], v[146:147], v[254:255] op_sel:[0,1]
v_pk_mul_f32 v[148:149], v[148:149], v[254:255] op_sel:[0,1]
v_pk_mul_f32 v[150:151], v[150:151], v[254:255] op_sel:[0,1]
s_waitcnt lgkmcnt(1)
v_pk_mul_f32 v[152:153], v[152:153], v[254:255]
v_pk_mul_f32 v[154:155], v[154:155], v[254:255] op_sel:[0,1]
v_pk_mul_f32 v[156:157], v[156:157], v[254:255] op_sel:[0,1]
v_pk_mul_f32 v[158:159], v[158:159], v[254:255] op_sel:[0,1]
v_mfma_f32_16x16x32_bf16 v[180:183], v[120:123], v[240:243], 0
v_mfma_f32_16x16x32_bf16 v[184:187], v[128:131], v[240:243], 0
v_mfma_f32_16x16x32_bf16 v[188:191], v[136:139], v[240:243], 0
v_mfma_f32_16x16x32_bf16 v[192:195], v[144:147], v[240:243], 0
v_mfma_f32_16x16x32_bf16 v[196:199], v[152:155], v[240:243], 0
v_mfma_f32_16x16x32_bf16 v[180:183], v[124:127], v[244:247], v[180:183]
v_mfma_f32_16x16x32_bf16 v[184:187], v[132:135], v[244:247], v[184:187]
v_mfma_f32_16x16x32_bf16 v[188:191], v[140:143], v[244:247], v[188:191]
v_mfma_f32_16x16x32_bf16 v[192:195], v[148:151], v[244:247], v[192:195]
v_mfma_f32_16x16x32_bf16 v[196:199], v[156:159], v[244:247], v[196:199]
L_2_e2:
s_branch L_2_go
L_b1:
s_sub_u32 s33, s22, 4
s_cmp_ge_u32 s20, 3
s_cselect_b32 s27, 7, 6
s_mul_i32 s28, s27, s45
s_add_u32 s44, s44, s28
s_lshl_b32 s45, s45, 1
s_sub_u32 s46, 11, s27
s_lshr_b32 s46, s46, 1
s_cmp_ge_u32 s20, 6
s_cselect_b32 s46, 0, s46
s_lshr_b32 s23, s33, 1
s_lshl_b32 s23, s23, 3
s_add_u32 s23, s23, s21
s_and_b32 s26, s33, 1
s_and_b32 s24, s20, 3
s_lshr_b32 s25, s20, 2
s_sub_u32 s27, 2048, s23
s_cmp_eq_u32 s23, 0
s_cselect_b32 s27, 32, s27
s_cselect_b32 s28, 64, -64
s_cmp_eq_u32 s25, 0
s_cselect_b32 s27, s23, s27
s_cselect_b32 s28, 64, s28
s_lshl_b32 s29, s24, 3
v_lshrrev_b32 v2, 3, v0
v_add_u32 v2, s29, v2
v_mul_i32_i24 v2, s28, v2
v_add_u32 v2, s27, v2
v_lshrrev_b32 v3, 4, v0
v_lshlrev_b32 v3, 1, v3
v_and_b32 v4, 7, v0
v_xor_b32 v3, v3, v4
v_mul_u32_u24 v2, 1280, v2
v_lshl_add_u32 v15, v3, 4, v2
s_mul_i32 s30, s26, 640
s_lshl_b32 s31, s20, 10
s_lshl_b32 s29, s30, 6
s_add_u32 m0, s29, s31
s_nop 0
buffer_load_dwordx4 v15, s[4:7], s30 offen lds
s_add_u32 m0, m0, 8192
s_add_u32 s30, s30, 128
buffer_load_dwordx4 v15, s[4:7], s30 offen lds
s_add_u32 m0, m0, 8192
s_add_u32 s30, s30, 128
buffer_load_dwordx4 v15, s[4:7], s30 offen lds
s_add_u32 m0, m0, 8192
s_add_u32 s30, s30, 128
s_load_dwordx2 s[92:93], s[0:1], 72
s_and_b32 s84, s22, 7
s_lshr_b32 s86, s22, 4
s_lshl_b32 s86, s86, 3
s_add_u32 s86, s86, s21
s_sub_u32 s87, 32, s86
s_cmp_eq_u32 s86, 0
s_cselect_b32 s87, 16, s87
s_bitcmp1_b32 s22, 3
s_cselect_b32 s85, s87, s86
s_mov_b32 s94, 2621440
s_mov_b32 s95, 0x20000
s_load_dwordx2 s[16:17], s[0:1], 80
s_mov_b32 s18, 256
v_and_b32 v13, 15, v0
v_lshrrev_b32 v14, 4, v0
s_mul_i32 s35, s26, 0x80008000
s_cmp_eq_u32 s25, 0
s_cbranch_scc1 L_b_gs
s_add_u32 s27, s24, 1
s_and_b32 s27, s27, 2
s_cselect_b32 s48, 0x41800000, 0
s_cselect_b32 s49, 0xbe800000, 0
s_mov_b32 s50, 0
s_mov_b32 s51, 1.0
s_mov_b32 s53, 1.0
s_and_b32 s27, s24, 1
s_cselect_b32 s52, -1.0, 1.0
s_mov_b32 s54, s52
s_cmp_lg_u32 s23, 0
s_cbranch_scc1 L_b_g0
s_and_b32 s27, s24, 1
s_cselect_b32 s49, 0xbe800000, 0
s_cselect_b32 s53, 0, 1.0
s_cmp_ge_u32 s24, 2
s_cselect_b32 s50, 0x3c800000, 0
s_cselect_b32 s51, 0, 1.0
s_cselect_b32 s52, s52, 0
s_cselect_b32 s54, 1.0, -1.0
s_and_b32 s27, s24, 1
s_cselect_b32 s54, s54, 0
L_b_g0:
v_cvt_f32_u32 v4, v13
v_cmp_eq_u32 vcc, 0, v13
v_mov_b32 v5, s49
v_fmac_f32 v5, s50, v4
v_mov_b32 v6, s48
v_cndmask_b32 v4, v4, v6, vcc
v_mul_f32 v4, 0x3d000000, v4
v_cndmask_b32 v5, v5, 0, vcc
v_mov_b32 v6, s51
v_mov_b32 v7, s53
v_cndmask_b32 v6, v6, v7, vcc
v_mov_b32 v7, s52
v_mov_b32 v8, s54
v_cndmask_b32 v7, v7, v8, vcc
v_lshrrev_b32 v8, 1, v14
v_and_b32 v9, 1, v14
v_lshlrev_b32 v9, 2, v9
v_lshl_add_u32 v8, v8, 4, v9
v_cvt_f32_u32 v8, v8
v_fmac_f32 v5, v4, v8
v_cos_f32 v216, v5
v_add_f32 v5, v5, v4
v_cos_f32 v217, v5
v_add_f32 v5, v5, v4
v_cos_f32 v218, v5
v_add_f32 v5, v5, v4
v_cos_f32 v219, v5
v_fmac_f32 v5, 0x40a00000, v4
v_cos_f32 v220, v5
v_add_f32 v5, v5, v4
v_cos_f32 v221, v5
v_add_f32 v5, v5, v4
v_cos_f32 v222, v5
v_add_f32 v5, v5, v4
v_cos_f32 v223, v5
v_cmp_neq_f32 vcc, 0, v6
v_cmp_neq_f32 s[28:29], 0, v7
v_ashrrev_i32 v8, 31, v7
v_cndmask_b32 v6, 0, -1, vcc
v_cndmask_b32 v7, 0, -1, s[28:29]
v_and_b32 v8, 0x80008000, v8
v_cvt_pk_bf16_f32 v224, v216, v217
v_cvt_pk_bf16_f32 v225, v218, v219
v_cvt_pk_bf16_f32 v226, v220, v221
v_cvt_pk_bf16_f32 v227, v222, v223
v_and_b32 v120, v6, v224
v_bitop3_b32 v124, v224, v7, v8 bitop3:0x6a
v_and_b32 v121, v6, v225
v_bitop3_b32 v125, v225, v7, v8 bitop3:0x6a
v_and_b32 v122, v6, v226
v_bitop3_b32 v126, v226, v7, v8 bitop3:0x6a
v_and_b32 v123, v6, v227
v_bitop3_b32 v127, v227, v7, v8 bitop3:0x6a
v_xor_b32 v128, s35, v120
v_xor_b32 v129, s35, v121
v_xor_b32 v130, s35, v122
v_xor_b32 v131, s35, v123
v_xor_b32 v132, s35, v124
v_xor_b32 v133, s35, v125
v_xor_b32 v134, s35, v126
v_xor_b32 v135, s35, v127
s_lshl_b32 s27, s24, 12
s_add_u32 s27, s27, 122880
v_lshl_add_u32 v4, v0, 4, s27
ds_write_b128 v4, v[120:123] offset:0
ds_write_b128 v4, v[124:127] offset:1024
ds_write_b128 v4, v[128:131] offset:2048
ds_write_b128 v4, v[132:135] offset:3072
L_b_gs:
s_and_b32 s24, s20, 1
s_lshl_b32 s27, s24, 13
s_add_u32 s27, s27, 122880
v_lshl_add_u32 v18, v0, 4, s27
s_lshl1_add_u32 s24, s24, 1
v_bfe_u32 v10, v0, 2, 3
v_lshrrev_b32 v11, 5, v0
v_lshl_add_u32 v11, v11, 4, v10
v_lshlrev_b32 v11, 7, v11
v_and_b32 v10, 6, v10
v_bfe_u32 v8, v0, 1, 1
s_and_b32 s27, s20, 2
v_or_b32 v8, s27, v8
v_xor_b32 v10, v10, v8
v_lshl_add_u32 v11, v10, 4, v11
v_and_b32 v10, 1, v0
v_lshl_add_u32 v2, v10, 3, v11
s_lshl_b32 s28, s25, 13
v_add_u32 v2, s28, v2
v_xor_b32 v3, 64, v2
v_add_u32 v4, 40960, v2
v_add_u32 v5, 40960, v3
s_lshl_b32 s27, s27, 2
s_lshl_b32 s28, s25, 11
s_add_u32 s27, s27, s28
s_mul_i32 s28, s24, 5120
s_add_u32 s27, s27, s28
s_add_u32 s27, s27, 81920
v_lshl_add_u32 v10, v0, 4, s27
v_add_u32 v11, 20480, v10
v_subrev_u32 v16, 5120, v10
s_cmp_eq_u32 s26, 0
s_cselect_b64 vcc, -1, 0
s_xor_b32 s27, s24, 3
s_or_b32 s27, s27, s23
s_cselect_b32 s28, 0, 0x00010001
s_or_b32 vcc_lo, vcc_lo, s28
s_or_b32 vcc_hi, vcc_hi, s28
v_cndmask_b32 v6, v11, v10, vcc
v_cndmask_b32 v7, v10, v11, vcc
v_mov_b32 v10, s35
v_cndmask_b32 v17, 0, v10, vcc
s_sub_u32 s27, 3, s26
s_cmp_lt_u32 s20, s27
s_cselect_b32 s50, 1, 0
s_cselect_b32 s49, 0, 2
s_mul_i32 s28, s26, 5
s_add_u32 s28, s28, s20
s_sub_u32 s28, s28, 3
s_lshl_b32 s29, s20, 1
s_cmp_lg_u32 s50, 0
s_cselect_b32 s48, s29, s28
s_cmp_lg_u32 s26, 0
s_cselect_b32 s49, 1, s49
v_lshlrev_b32 v8, 2, v14
v_cvt_f32_u32 v24, v8
v_add_f32 v25, 1.0, v24
v_add_f32 v26, 2.0, v24
v_add_f32 v27, 2.0, v25
s_lshl_b32 s27, s48, 6
s_add_u32 s27, s27, s49
s_add_u32 s27, s27, 0
v_lshl_add_u32 v28, v13, 2, s27
v_cvt_f32_u32 v28, v28
v_mul_f32 v28, 0x3acccccd, v28
v_mul_f32 v234, v28, v24
v_mul_f32 v235, v28, v25
v_mul_f32 v236, v28, v26
v_mul_f32 v237, v28, v27
v_mul_f32 v233, 0x41800000, v28
v_cos_f32 v216, v234
v_sin_f32 v220, v234
v_cos_f32 v217, v235
v_sin_f32 v221, v235
buffer_load_dwordx4 v15, s[4:7], s30 offen lds
s_add_u32 m0, m0, 8192
s_add_u32 s30, s30, 128
v_cos_f32 v218, v236
v_sin_f32 v222, v236
v_cos_f32 v219, v237
v_sin_f32 v223, v237
v_add_f32 v234, v233, v234
v_add_f32 v235, v233, v235
v_add_f32 v236, v233, v236
v_add_f32 v237, v233, v237
v_cos_f32 v224, v234
v_sin_f32 v228, v234
v_cos_f32 v225, v235
v_sin_f32 v229, v235
v_cos_f32 v226, v236
v_sin_f32 v230, v236
v_cos_f32 v227, v237
v_sin_f32 v231, v237
v_cos_f32 v232, v233
v_cvt_pk_bf16_f32 v40, v216, v217
v_cvt_pk_bf16_f32 v41, v218, v219
v_cvt_pk_bf16_f32 v60, v220, v221
v_cvt_pk_bf16_f32 v61, v222, v223
v_add_f32 v232, v232, v232
v_cvt_pk_bf16_f32 v42, v224, v225
v_cvt_pk_bf16_f32 v43, v226, v227
v_cvt_pk_bf16_f32 v62, v228, v229
v_cvt_pk_bf16_f32 v63, v230, v231
v_pk_fma_f32 v[216:217], v[224:225], v[232:233], v[216:217] op_sel_hi:[1,0,1] neg_lo:[0,0,1] neg_hi:[0,0,1]
v_pk_fma_f32 v[218:219], v[226:227], v[232:233], v[218:219] op_sel_hi:[1,0,1] neg_lo:[0,0,1] neg_hi:[0,0,1]
v_pk_fma_f32 v[220:221], v[228:229], v[232:233], v[220:221] op_sel_hi:[1,0,1] neg_lo:[0,0,1] neg_hi:[0,0,1]
v_pk_fma_f32 v[222:223], v[230:231], v[232:233], v[222:223] op_sel_hi:[1,0,1] neg_lo:[0,0,1] neg_hi:[0,0,1]
buffer_load_dwordx4 v15, s[4:7], s30 offen lds
s_xor_b32 s30, s26, 1
s_mul_i32 s30, s30, 640
s_lshl_b32 s34, s30, 6
s_add_u32 m0, s34, s31
v_cvt_pk_bf16_f32 v44, v216, v217
v_cvt_pk_bf16_f32 v45, v218, v219
v_cvt_pk_bf16_f32 v64, v220, v221
v_cvt_pk_bf16_f32 v65, v222, v223
v_pk_fma_f32 v[224:225], v[216:217], v[232:233], v[224:225] op_sel_hi:[1,0,1] neg_lo:[0,0,1] neg_hi:[0,0,1]
v_pk_fma_f32 v[226:227], v[218:219], v[232:233], v[226:227] op_sel_hi:[1,0,1] neg_lo:[0,0,1] neg_hi:[0,0,1]
v_pk_fma_f32 v[228:229], v[220:221], v[232:233], v[228:229] op_sel_hi:[1,0,1] neg_lo:[0,0,1] neg_hi:[0,0,1]
v_pk_fma_f32 v[230:231], v[222:223], v[232:233], v[230:231] op_sel_hi:[1,0,1] neg_lo:[0,0,1] neg_hi:[0,0,1]
v_cvt_pk_bf16_f32 v46, v224, v225
v_cvt_pk_bf16_f32 v47, v226, v227
v_cvt_pk_bf16_f32 v66, v228, v229
v_cvt_pk_bf16_f32 v67, v230, v231
v_pk_fma_f32 v[216:217], v[224:225], v[232:233], v[216:217] op_sel_hi:[1,0,1] neg_lo:[0,0,1] neg_hi:[0,0,1]
v_pk_fma_f32 v[218:219], v[226:227], v[232:233], v[218:219] op_sel_hi:[1,0,1] neg_lo:[0,0,1] neg_hi:[0,0,1]
v_pk_fma_f32 v[220:221], v[228:229], v[232:233], v[220:221] op_sel_hi:[1,0,1] neg_lo:[0,0,1] neg_hi:[0,0,1]
v_pk_fma_f32 v[222:223], v[230:231], v[232:233], v[222:223] op_sel_hi:[1,0,1] neg_lo:[0,0,1] neg_hi:[0,0,1]
v_cvt_pk_bf16_f32 v48, v216, v217
v_cvt_pk_bf16_f32 v49, v218, v219
v_cvt_pk_bf16_f32 v68, v220, v221
v_cvt_pk_bf16_f32 v69, v222, v223
v_pk_fma_f32 v[224:225], v[216:217], v[232:233], v[224:225] op_sel_hi:[1,0,1] neg_lo:[0,0,1] neg_hi:[0,0,1]
v_pk_fma_f32 v[226:227], v[218:219], v[232:233], v[226:227] op_sel_hi:[1,0,1] neg_lo:[0,0,1] neg_hi:[0,0,1]
v_pk_fma_f32 v[228:229], v[220:221], v[232:233], v[228:229] op_sel_hi:[1,0,1] neg_lo:[0,0,1] neg_hi:[0,0,1]
v_pk_fma_f32 v[230:231], v[222:223], v[232:233], v[230:231] op_sel_hi:[1,0,1] neg_lo:[0,0,1] neg_hi:[0,0,1]
v_cvt_pk_bf16_f32 v50, v224, v225
v_cvt_pk_bf16_f32 v51, v226, v227
v_cvt_pk_bf16_f32 v70, v228, v229
v_cvt_pk_bf16_f32 v71, v230, v231
v_pk_fma_f32 v[216:217], v[224:225], v[232:233], v[216:217] op_sel_hi:[1,0,1] neg_lo:[0,0,1] neg_hi:[0,0,1]
v_pk_fma_f32 v[218:219], v[226:227], v[232:233], v[218:219] op_sel_hi:[1,0,1] neg_lo:[0,0,1] neg_hi:[0,0,1]
buffer_load_dwordx4 v15, s[4:7], s30 offen lds
s_add_u32 m0, m0, 8192
s_add_u32 s30, s30, 128
v_pk_fma_f32 v[220:221], v[228:229], v[232:233], v[220:221] op_sel_hi:[1,0,1] neg_lo:[0,0,1] neg_hi:[0,0,1]
v_pk_fma_f32 v[222:223], v[230:231], v[232:233], v[222:223] op_sel_hi:[1,0,1] neg_lo:[0,0,1] neg_hi:[0,0,1]
v_cvt_pk_bf16_f32 v52, v216, v217
v_cvt_pk_bf16_f32 v53, v218, v219
v_cvt_pk_bf16_f32 v72, v220, v221
v_cvt_pk_bf16_f32 v73, v222, v223
v_pk_fma_f32 v[224:225], v[216:217], v[232:233], v[224:225] op_sel_hi:[1,0,1] neg_lo:[0,0,1] neg_hi:[0,0,1]
v_pk_fma_f32 v[226:227], v[218:219], v[232:233], v[226:227] op_sel_hi:[1,0,1] neg_lo:[0,0,1] neg_hi:[0,0,1]
v_pk_fma_f32 v[228:229], v[220:221], v[232:233], v[228:229] op_sel_hi:[1,0,1] neg_lo:[0,0,1] neg_hi:[0,0,1]
v_pk_fma_f32 v[230:231], v[222:223], v[232:233], v[230:231] op_sel_hi:[1,0,1] neg_lo:[0,0,1] neg_hi:[0,0,1]
v_cvt_pk_bf16_f32 v54, v224, v225
v_cvt_pk_bf16_f32 v55, v226, v227
v_cvt_pk_bf16_f32 v74, v228, v229
v_cvt_pk_bf16_f32 v75, v230, v231
v_pk_fma_f32 v[216:217], v[224:225], v[232:233], v[216:217] op_sel_hi:[1,0,1] neg_lo:[0,0,1] neg_hi:[0,0,1]
v_pk_fma_f32 v[218:219], v[226:227], v[232:233], v[218:219] op_sel_hi:[1,0,1] neg_lo:[0,0,1] neg_hi:[0,0,1]
v_pk_fma_f32 v[220:221], v[228:229], v[232:233], v[220:221] op_sel_hi:[1,0,1] neg_lo:[0,0,1] neg_hi:[0,0,1]
v_pk_fma_f32 v[222:223], v[230:231], v[232:233], v[222:223] op_sel_hi:[1,0,1] neg_lo:[0,0,1] neg_hi:[0,0,1]
v_cvt_pk_bf16_f32 v56, v216, v217
v_cvt_pk_bf16_f32 v57, v218, v219
v_cvt_pk_bf16_f32 v76, v220, v221
v_cvt_pk_bf16_f32 v77, v222, v223
v_pk_fma_f32 v[224:225], v[216:217], v[232:233], v[224:225] op_sel_hi:[1,0,1] neg_lo:[0,0,1] neg_hi:[0,0,1]
v_pk_fma_f32 v[226:227], v[218:219], v[232:233], v[226:227] op_sel_hi:[1,0,1] neg_lo:[0,0,1] neg_hi:[0,0,1]
v_pk_fma_f32 v[228:229], v[220:221], v[232:233], v[228:229] op_sel_hi:[1,0,1] neg_lo:[0,0,1] neg_hi:[0,0,1]
v_pk_fma_f32 v[230:231], v[222:223], v[232:233], v[230:231] op_sel_hi:[1,0,1] neg_lo:[0,0,1] neg_hi:[0,0,1]
v_cvt_pk_bf16_f32 v58, v224, v225
v_cvt_pk_bf16_f32 v59, v226, v227
v_cvt_pk_bf16_f32 v78, v228, v229
v_cvt_pk_bf16_f32 v79, v230, v231
buffer_load_dwordx4 v15, s[4:7], s30 offen lds
s_add_u32 m0, m0, 8192
s_add_u32 s30, s30, 128
buffer_load_dwordx4 v15, s[4:7], s30 offen lds
s_add_u32 m0, m0, 8192
s_add_u32 s30, s30, 128
buffer_load_dwordx4 v15, s[4:7], s30 offen lds
s_add_u32 m0, m0, 8192
s_add_u32 s30, s30, 128
buffer_load_dwordx4 v15, s[4:7], s30 offen lds
s_add_u32 m0, m0, 8192
s_add_u32 s30, s30, 128
s_cmp_eq_u32 s50, 0
s_cbranch_scc1 L_b_gd
s_lshl_b32 s27, s48, 6
s_add_u32 s27, s27, s49
s_add_u32 s27, s27, 64
v_lshl_add_u32 v28, v13, 2, s27
v_cvt_f32_u32 v28, v28
v_mul_f32 v28, 0x3acccccd, v28
v_mul_f32 v234, v28, v24
v_mul_f32 v235, v28, v25
v_mul_f32 v236, v28, v26
v_mul_f32 v237, v28, v27
v_mul_f32 v233, 0x41800000, v28
v_cos_f32 v216, v234
v_sin_f32 v220, v234
v_cos_f32 v217, v235
v_sin_f32 v221, v235
v_cos_f32 v218, v236
v_sin_f32 v222, v236
v_cos_f32 v219, v237
v_sin_f32 v223, v237
v_add_f32 v234, v233, v234
v_add_f32 v235, v233, v235
v_add_f32 v236, v233, v236
v_add_f32 v237, v233, v237
v_cos_f32 v224, v234
v_sin_f32 v228, v234
v_cos_f32 v225, v235
v_sin_f32 v229, v235
v_cos_f32 v226, v236
v_sin_f32 v230, v236
v_cos_f32 v227, v237
v_sin_f32 v231, v237
v_cos_f32 v232, v233
v_cvt_pk_bf16_f32 v80, v216, v217
v_cvt_pk_bf16_f32 v81, v218, v219
v_cvt_pk_bf16_f32 v100, v220, v221
v_cvt_pk_bf16_f32 v101, v222, v223
v_add_f32 v232, v232, v232
v_cvt_pk_bf16_f32 v82, v224, v225
v_cvt_pk_bf16_f32 v83, v226, v227
v_cvt_pk_bf16_f32 v102, v228, v229
v_cvt_pk_bf16_f32 v103, v230, v231
v_pk_fma_f32 v[216:217], v[224:225], v[232:233], v[216:217] op_sel_hi:[1,0,1] neg_lo:[0,0,1] neg_hi:[0,0,1]
v_pk_fma_f32 v[218:219], v[226:227], v[232:233], v[218:219] op_sel_hi:[1,0,1] neg_lo:[0,0,1] neg_hi:[0,0,1]
v_pk_fma_f32 v[220:221], v[228:229], v[232:233], v[220:221] op_sel_hi:[1,0,1] neg_lo:[0,0,1] neg_hi:[0,0,1]
v_pk_fma_f32 v[222:223], v[230:231], v[232:233], v[222:223] op_sel_hi:[1,0,1] neg_lo:[0,0,1] neg_hi:[0,0,1]
v_cvt_pk_bf16_f32 v84, v216, v217
v_cvt_pk_bf16_f32 v85, v218, v219
v_cvt_pk_bf16_f32 v104, v220, v221
v_cvt_pk_bf16_f32 v105, v222, v223
v_pk_fma_f32 v[224:225], v[216:217], v[232:233], v[224:225] op_sel_hi:[1,0,1] neg_lo:[0,0,1] neg_hi:[0,0,1]
v_pk_fma_f32 v[226:227], v[218:219], v[232:233], v[226:227] op_sel_hi:[1,0,1] neg_lo:[0,0,1] neg_hi:[0,0,1]
v_pk_fma_f32 v[228:229], v[220:221], v[232:233], v[228:229] op_sel_hi:[1,0,1] neg_lo:[0,0,1] neg_hi:[0,0,1]
v_pk_fma_f32 v[230:231], v[222:223], v[232:233], v[230:231] op_sel_hi:[1,0,1] neg_lo:[0,0,1] neg_hi:[0,0,1]
v_cvt_pk_bf16_f32 v86, v224, v225
v_cvt_pk_bf16_f32 v87, v226, v227
v_cvt_pk_bf16_f32 v106, v228, v229
v_cvt_pk_bf16_f32 v107, v230, v231
v_pk_fma_f32 v[216:217], v[224:225], v[232:233], v[216:217] op_sel_hi:[1,0,1] neg_lo:[0,0,1] neg_hi:[0,0,1]
v_pk_fma_f32 v[218:219], v[226:227], v[232:233], v[218:219] op_sel_hi:[1,0,1] neg_lo:[0,0,1] neg_hi:[0,0,1]
v_pk_fma_f32 v[220:221], v[228:229], v[232:233], v[220:221] op_sel_hi:[1,0,1] neg_lo:[0,0,1] neg_hi:[0,0,1]
v_pk_fma_f32 v[222:223], v[230:231], v[232:233], v[222:223] op_sel_hi:[1,0,1] neg_lo:[0,0,1] neg_hi:[0,0,1]
v_cvt_pk_bf16_f32 v88, v216, v217
v_cvt_pk_bf16_f32 v89, v218, v219
v_cvt_pk_bf16_f32 v108, v220, v221
v_cvt_pk_bf16_f32 v109, v222, v223
v_pk_fma_f32 v[224:225], v[216:217], v[232:233], v[224:225] op_sel_hi:[1,0,1] neg_lo:[0,0,1] neg_hi:[0,0,1]
v_pk_fma_f32 v[226:227], v[218:219], v[232:233], v[226:227] op_sel_hi:[1,0,1] neg_lo:[0,0,1] neg_hi:[0,0,1]
v_pk_fma_f32 v[228:229], v[220:221], v[232:233], v[228:229] op_sel_hi:[1,0,1] neg_lo:[0,0,1] neg_hi:[0,0,1]
v_pk_fma_f32 v[230:231], v[222:223], v[232:233], v[230:231] op_sel_hi:[1,0,1] neg_lo:[0,0,1] neg_hi:[0,0,1]
v_cvt_pk_bf16_f32 v90, v224, v225
v_cvt_pk_bf16_f32 v91, v226, v227
v_cvt_pk_bf16_f32 v110, v228, v229
v_cvt_pk_bf16_f32 v111, v230, v231
v_pk_fma_f32 v[216:217], v[224:225], v[232:233], v[216:217] op_sel_hi:[1,0,1] neg_lo:[0,0,1] neg_hi:[0,0,1]
v_pk_fma_f32 v[218:219], v[226:227], v[232:233], v[218:219] op_sel_hi:[1,0,1] neg_lo:[0,0,1] neg_hi:[0,0,1]
v_pk_fma_f32 v[220:221], v[228:229], v[232:233], v[220:221] op_sel_hi:[1,0,1] neg_lo:[0,0,1] neg_hi:[0,0,1]
v_pk_fma_f32 v[222:223], v[230:231], v[232:233], v[222:223] op_sel_hi:[1,0,1] neg_lo:[0,0,1] neg_hi:[0,0,1]
v_cvt_pk_bf16_f32 v92, v216, v217
v_cvt_pk_bf16_f32 v93, v218, v219
v_cvt_pk_bf16_f32 v112, v220, v221
v_cvt_pk_bf16_f32 v113, v222, v223
v_pk_fma_f32 v[224:225], v[216:217], v[232:233], v[224:225] op_sel_hi:[1,0,1] neg_lo:[0,0,1] neg_hi:[0,0,1]
v_pk_fma_f32 v[226:227], v[218:219], v[232:233], v[226:227] op_sel_hi:[1,0,1] neg_lo:[0,0,1] neg_hi:[0,0,1]
v_pk_fma_f32 v[228:229], v[220:221], v[232:233], v[228:229] op_sel_hi:[1,0,1] neg_lo:[0,0,1] neg_hi:[0,0,1]
v_pk_fma_f32 v[230:231], v[222:223], v[232:233], v[230:231] op_sel_hi:[1,0,1] neg_lo:[0,0,1] neg_hi:[0,0,1]
v_cvt_pk_bf16_f32 v94, v224, v225
v_cvt_pk_bf16_f32 v95, v226, v227
v_cvt_pk_bf16_f32 v114, v228, v229
v_cvt_pk_bf16_f32 v115, v230, v231
v_pk_fma_f32 v[216:217], v[224:225], v[232:233], v[216:217] op_sel_hi:[1,0,1] neg_lo:[0,0,1] neg_hi:[0,0,1]
v_pk_fma_f32 v[218:219], v[226:227], v[232:233], v[218:219] op_sel_hi:[1,0,1] neg_lo:[0,0,1] neg_hi:[0,0,1]
v_pk_fma_f32 v[220:221], v[228:229], v[232:233], v[220:221] op_sel_hi:[1,0,1] neg_lo:[0,0,1] neg_hi:[0,0,1]
v_pk_fma_f32 v[222:223], v[230:231], v[232:233], v[222:223] op_sel_hi:[1,0,1] neg_lo:[0,0,1] neg_hi:[0,0,1]
v_cvt_pk_bf16_f32 v96, v216, v217
v_cvt_pk_bf16_f32 v97, v218, v219
v_cvt_pk_bf16_f32 v116, v220, v221
v_cvt_pk_bf16_f32 v117, v222, v223
v_pk_fma_f32 v[224:225], v[216:217], v[232:233], v[224:225] op_sel_hi:[1,0,1] neg_lo:[0,0,1] neg_hi:[0,0,1]
v_pk_fma_f32 v[226:227], v[218:219], v[232:233], v[226:227] op_sel_hi:[1,0,1] neg_lo:[0,0,1] neg_hi:[0,0,1]
v_pk_fma_f32 v[228:229], v[220:221], v[232:233], v[228:229] op_sel_hi:[1,0,1] neg_lo:[0,0,1] neg_hi:[0,0,1]
v_pk_fma_f32 v[230:231], v[222:223], v[232:233], v[230:231] op_sel_hi:[1,0,1] neg_lo:[0,0,1] neg_hi:[0,0,1]
v_cvt_pk_bf16_f32 v98, v224, v225
v_cvt_pk_bf16_f32 v99, v226, v227
v_cvt_pk_bf16_f32 v118, v228, v229
v_cvt_pk_bf16_f32 v119, v230, v231
L_b_gd:
s_mul_i32 s51, s26, -128
s_add_u32 s51, s51, 768
s_lshl_b32 s27, s51, 2
v_mul_u32_u24 v8, s27, v14
s_mul_i32 s27, s51, 29
v_sub_u32 v9, s27, v8
v_cmp_eq_u32 s[54:55], 0, v14
s_mul_i32 s27, s51, 13
v_mov_b32 v10, s27
s_cmp_eq_u32 s23, 0
v_cndmask_b32 v10, v9, v10, s[54:55]
s_cselect_b64 s[56:57], s[54:55], 0
s_lshr_b32 s27, s49, 1
s_mul_i32 s27, s27, 20480
s_add_u32 s27, s27, 81920
v_lshl_add_u32 v11, v0, 4, s27
s_waitcnt vmcnt(0) lgkmcnt(0)
s_barrier
ds_read_b128 v[120:123], v18 offset:0
ds_read_b128 v[124:127], v18 offset:1024
ds_read_b128 v[128:131], v18 offset:2048
ds_read_b128 v[132:135], v18 offset:3072
ds_read_b128 v[136:139], v18 offset:4096
ds_read_b128 v[140:143], v18 offset:5120
ds_read_b128 v[144:147], v18 offset:6144
ds_read_b128 v[148:151], v18 offset:7168
ds_read_b64_tr_b16 v[152:153], v2 offset:0
ds_read_b64_tr_b16 v[154:155], v2 offset:1024
ds_read_b64_tr_b16 v[156:157], v2 offset:4096
ds_read_b64_tr_b16 v[158:159], v2 offset:5120
ds_read_b64_tr_b16 v[160:161], v3 offset:16384
ds_read_b64_tr_b16 v[162:163], v3 offset:17408
ds_read_b64_tr_b16 v[164:165], v3 offset:20480
ds_read_b64_tr_b16 v[166:167], v3 offset:21504
ds_read_b64_tr_b16 v[168:169], v4 offset:0
ds_read_b64_tr_b16 v[170:171], v4 offset:1024
ds_read_b64_tr_b16 v[172:173], v4 offset:4096
ds_read_b64_tr_b16 v[174:175], v4 offset:5120
ds_read_b64_tr_b16 v[176:177], v5 offset:16384
ds_read_b64_tr_b16 v[178:179], v5 offset:17408
ds_read_b64_tr_b16 v[180:181], v5 offset:20480
ds_read_b64_tr_b16 v[182:183], v5 offset:21504
s_cmp_lt_u32 s20, 3
s_cbranch_scc0 L_bg1
s_sub_i32 s46, s46, 1
s_cmp_lt_i32 s46, 0
s_cbranch_scc1 L_bg1
buffer_load_dword v1, v12, s[40:43], s44 offen
s_add_u32 s44, s44, s45
L_bg1:
s_cmp_eq_u32 s25, 0
s_cbranch_scc1 L_b_pr
s_setprio 1
L_b_pr:
s_waitcnt lgkmcnt(0)
v_mfma_f32_16x16x32_bf16 v[216:219], v[152:155], v[120:123], 0
ds_read_b64_tr_b16 v[184:185], v3 offset:0
ds_read_b64_tr_b16 v[186:187], v3 offset:1024
v_mfma_f32_16x16x32_bf16 v[224:227], v[152:155], v[136:139], 0
ds_read_b64_tr_b16 v[188:189], v3 offset:4096
ds_read_b64_tr_b16 v[190:191], v3 offset:5120
v_mfma_f32_16x16x32_bf16 v[220:223], v[160:163], v[128:131], 0
ds_read_b64_tr_b16 v[192:193], v2 offset:24576
ds_read_b64_tr_b16 v[194:195], v2 offset:25600
v_mfma_f32_16x16x32_bf16 v[228:231], v[160:163], v[136:139], 0
ds_read_b64_tr_b16 v[196:197], v2 offset:28672
ds_read_b64_tr_b16 v[198:199], v2 offset:29696
v_mfma_f32_16x16x32_bf16 v[216:219], v[156:159], v[124:127], v[216:219]
ds_read_b64_tr_b16 v[200:201], v5 offset:0
ds_read_b64_tr_b16 v[202:203], v5 offset:1024
v_mfma_f32_16x16x32_bf16 v[224:227], v[156:159], v[140:143], v[224:227]
ds_read_b64_tr_b16 v[204:205], v5 offset:4096
ds_read_b64_tr_b16 v[206:207], v5 offset:5120
v_mfma_f32_16x16x32_bf16 v[220:223], v[164:167], v[132:135], v[220:223]
ds_read_b64_tr_b16 v[208:209], v4 offset:24576
ds_read_b64_tr_b16 v[210:211], v4 offset:25600
v_mfma_f32_16x16x32_bf16 v[228:231], v[164:167], v[140:143], v[228:231]
ds_read_b64_tr_b16 v[212:213], v4 offset:28672
ds_read_b64_tr_b16 v[214:215], v4 offset:29696
v_mfma_f32_16x16x32_bf16 v[216:219], v[168:171], v[128:131], v[216:219]
v_mfma_f32_16x16x32_bf16 v[224:227], v[168:171], v[144:147], v[224:227]
v_mfma_f32_16x16x32_bf16 v[220:223], v[176:179], v[120:123], v[220:223]
v_mfma_f32_16x16x32_bf16 v[228:231], v[176:179], v[144:147], v[228:231]
v_mfma_f32_16x16x32_bf16 v[216:219], v[172:175], v[132:135], v[216:219]
v_mfma_f32_16x16x32_bf16 v[224:227], v[172:175], v[148:151], v[224:227]
v_mfma_f32_16x16x32_bf16 v[220:223], v[180:183], v[124:127], v[220:223]
v_mfma_f32_16x16x32_bf16 v[228:231], v[180:183], v[148:151], v[228:231]
s_cmp_lt_u32 s20, 3
s_cbranch_scc1 L_bg2
s_sub_i32 s46, s46, 1
s_cmp_lt_i32 s46, 0
s_cbranch_scc1 L_bg2
buffer_load_dword v1, v12, s[40:43], s44 offen
s_add_u32 s44, s44, s45
L_bg2:
s_waitcnt lgkmcnt(0)
s_cmp_eq_u32 s26, 0
s_cbranch_scc1 L_b_ev
s_cmp_eq_u32 s25, 0
s_cbranch_scc1 L_b_s21
v_mfma_f32_16x16x32_bf16 v[232:235], v[184:187], v[120:123], 0
ds_read_b64_tr_b16 v[152:153], v2 offset:8192
ds_read_b64_tr_b16 v[154:155], v2 offset:9216
v_mfma_f32_16x16x32_bf16 v[240:243], v[184:187], v[136:139], 0
ds_read_b64_tr_b16 v[156:157], v2 offset:12288
ds_read_b64_tr_b16 v[158:159], v2 offset:13312
v_mfma_f32_16x16x32_bf16 v[236:239], v[192:195], v[128:131], 0
ds_read_b64_tr_b16 v[160:161], v3 offset:24576
ds_read_b64_tr_b16 v[162:163], v3 offset:25600
v_mfma_f32_16x16x32_bf16 v[244:247], v[192:195], v[136:139], 0
ds_read_b64_tr_b16 v[164:165], v3 offset:28672
ds_read_b64_tr_b16 v[166:167], v3 offset:29696
v_mfma_f32_16x16x32_bf16 v[232:235], v[188:191], v[124:127], v[232:235]
ds_read_b64_tr_b16 v[168:169], v4 offset:8192
ds_read_b64_tr_b16 v[170:171], v4 offset:9216
v_mfma_f32_16x16x32_bf16 v[240:243], v[188:191], v[140:143], v[240:243]
ds_read_b64_tr_b16 v[172:173], v4 offset:12288
ds_read_b64_tr_b16 v[174:175], v4 offset:13312
v_mfma_f32_16x16x32_bf16 v[236:239], v[196:199], v[132:135], v[236:239]
ds_read_b64_tr_b16 v[176:177], v5 offset:24576
ds_read_b64_tr_b16 v[178:179], v5 offset:25600
v_mfma_f32_16x16x32_bf16 v[244:247], v[196:199], v[140:143], v[244:247]
ds_read_b64_tr_b16 v[180:181], v5 offset:28672
ds_read_b64_tr_b16 v[182:183], v5 offset:29696
v_mfma_f32_16x16x32_bf16 v[232:235], v[200:203], v[128:131], v[232:235]
v_cvt_pk_bf16_f32 v216, v216, v217
v_cvt_pk_bf16_f32 v217, v218, v219
v_mfma_f32_16x16x32_bf16 v[240:243], v[200:203], v[144:147], v[240:243]
v_cvt_pk_bf16_f32 v218, v220, v221
v_cvt_pk_bf16_f32 v219, v222, v223
v_mfma_f32_16x16x32_bf16 v[236:239], v[208:211], v[120:123], v[236:239]
ds_write_b64 v16, v[216:217] offset:0
ds_write_b64 v16, v[218:219] offset:20480
v_mfma_f32_16x16x32_bf16 v[244:247], v[208:211], v[144:147], v[244:247]
v_cvt_pk_bf16_f32 v224, v224, v225
v_cvt_pk_bf16_f32 v225, v226, v227
v_mfma_f32_16x16x32_bf16 v[232:235], v[204:207], v[132:135], v[232:235]
v_cvt_pk_bf16_f32 v226, v228, v229
v_cvt_pk_bf16_f32 v227, v230, v231
v_mfma_f32_16x16x32_bf16 v[240:243], v[204:207], v[148:151], v[240:243]
v_xor_b32 v226, v17, v226
v_xor_b32 v227, v17, v227
v_mfma_f32_16x16x32_bf16 v[236:239], v[212:215], v[124:127], v[236:239]
ds_write_b64 v6, v[224:225] offset:0
ds_write_b64 v7, v[226:227] offset:0
v_mfma_f32_16x16x32_bf16 v[244:247], v[212:215], v[148:151], v[244:247]
s_waitcnt lgkmcnt(4)
v_mfma_f32_16x16x32_bf16 v[216:219], v[152:155], v[120:123], 0
v_mfma_f32_16x16x32_bf16 v[224:227], v[152:155], v[136:139], 0
v_mfma_f32_16x16x32_bf16 v[220:223], v[160:163], v[128:131], 0
v_mfma_f32_16x16x32_bf16 v[228:231], v[160:163], v[136:139], 0
v_cvt_pk_bf16_f32 v232, v232, v233
v_cvt_pk_bf16_f32 v233, v234, v235
v_mfma_f32_16x16x32_bf16 v[216:219], v[156:159], v[124:127], v[216:219]
v_cvt_pk_bf16_f32 v234, v236, v237
v_cvt_pk_bf16_f32 v235, v238, v239
v_mfma_f32_16x16x32_bf16 v[224:227], v[156:159], v[140:143], v[224:227]
ds_write_b64 v16, v[232:233] offset:1024
ds_write_b64 v16, v[234:235] offset:21504
v_mfma_f32_16x16x32_bf16 v[220:223], v[164:167], v[132:135], v[220:223]
v_cvt_pk_bf16_f32 v240, v240, v241
v_cvt_pk_bf16_f32 v241, v242, v243
v_mfma_f32_16x16x32_bf16 v[228:231], v[164:167], v[140:143], v[228:231]
v_cvt_pk_bf16_f32 v242, v244, v245
v_cvt_pk_bf16_f32 v243, v246, v247
v_mfma_f32_16x16x32_bf16 v[216:219], v[168:171], v[128:131], v[216:219]
v_xor_b32 v242, v17, v242
v_xor_b32 v243, v17, v243
v_mfma_f32_16x16x32_bf16 v[224:227], v[168:171], v[144:147], v[224:227]
ds_write_b64 v6, v[240:241] offset:1024
ds_write_b64 v7, v[242:243] offset:1024
v_mfma_f32_16x16x32_bf16 v[220:223], v[176:179], v[120:123], v[220:223]
v_mfma_f32_16x16x32_bf16 v[228:231], v[176:179], v[144:147], v[228:231]
v_mfma_f32_16x16x32_bf16 v[216:219], v[172:175], v[132:135], v[216:219]
v_mfma_f32_16x16x32_bf16 v[224:227], v[172:175], v[148:151], v[224:227]
v_mfma_f32_16x16x32_bf16 v[220:223], v[180:183], v[124:127], v[220:223]
v_mfma_f32_16x16x32_bf16 v[228:231], v[180:183], v[148:151], v[228:231]
s_nop 4
v_cvt_pk_bf16_f32 v216, v216, v217
v_cvt_pk_bf16_f32 v217, v218, v219
v_cvt_pk_bf16_f32 v218, v220, v221
v_cvt_pk_bf16_f32 v219, v222, v223
ds_write_b64 v16, v[216:217] offset:2048
ds_write_b64 v16, v[218:219] offset:22528
v_cvt_pk_bf16_f32 v224, v224, v225
v_cvt_pk_bf16_f32 v225, v226, v227
v_cvt_pk_bf16_f32 v226, v228, v229
v_cvt_pk_bf16_f32 v227, v230, v231
v_xor_b32 v226, v17, v226
v_xor_b32 v227, v17, v227
ds_write_b64 v6, v[224:225] offset:2048
ds_write_b64 v7, v[226:227] offset:2048
s_branch L_b_s31
L_b_s21:
s_nop 3
v_mfma_f32_16x16x32_bf16 v[232:235], v[184:187], v[120:123], 0
v_mfma_f32_16x16x32_bf16 v[240:243], v[184:187], v[136:139], 0
v_mfma_f32_16x16x32_bf16 v[236:239], v[192:195], v[128:131], 0
v_mfma_f32_16x16x32_bf16 v[244:247], v[192:195], v[136:139], 0
v_cvt_pk_bf16_f32 v216, v216, v217
v_cvt_pk_bf16_f32 v217, v218, v219
v_mfma_f32_16x16x32_bf16 v[232:235], v[188:191], v[124:127], v[232:235]
v_cvt_pk_bf16_f32 v218, v220, v221
v_cvt_pk_bf16_f32 v219, v222, v223
v_mfma_f32_16x16x32_bf16 v[240:243], v[188:191], v[140:143], v[240:243]
ds_write_b64 v16, v[216:217] offset:0
ds_write_b64 v16, v[218:219] offset:20480
v_mfma_f32_16x16x32_bf16 v[236:239], v[196:199], v[132:135], v[236:239]
v_cvt_pk_bf16_f32 v224, v224, v225
v_cvt_pk_bf16_f32 v225, v226, v227
v_mfma_f32_16x16x32_bf16 v[244:247], v[196:199], v[140:143], v[244:247]
v_cvt_pk_bf16_f32 v226, v228, v229
v_cvt_pk_bf16_f32 v227, v230, v231
v_mfma_f32_16x16x32_bf16 v[232:235], v[200:203], v[128:131], v[232:235]
v_xor_b32 v226, v17, v226
v_xor_b32 v227, v17, v227
v_mfma_f32_16x16x32_bf16 v[240:243], v[200:203], v[144:147], v[240:243]
ds_write_b64 v6, v[224:225] offset:0
ds_write_b64 v7, v[226:227] offset:0
v_mfma_f32_16x16x32_bf16 v[236:239], v[208:211], v[120:123], v[236:239]
v_mfma_f32_16x16x32_bf16 v[244:247], v[208:211], v[144:147], v[244:247]
v_mfma_f32_16x16x32_bf16 v[232:235], v[204:207], v[132:135], v[232:235]
v_mfma_f32_16x16x32_bf16 v[240:243], v[204:207], v[148:151], v[240:243]
v_mfma_f32_16x16x32_bf16 v[236:239], v[212:215], v[124:127], v[236:239]
v_mfma_f32_16x16x32_bf16 v[244:247], v[212:215], v[148:151], v[244:247]
s_nop 4
v_cvt_pk_bf16_f32 v232, v232, v233
v_cvt_pk_bf16_f32 v233, v234, v235
v_cvt_pk_bf16_f32 v234, v236, v237
v_cvt_pk_bf16_f32 v235, v238, v239
ds_write_b64 v16, v[232:233] offset:1024
ds_write_b64 v16, v[234:235] offset:21504
v_cvt_pk_bf16_f32 v240, v240, v241
v_cvt_pk_bf16_f32 v241, v242, v243
v_cvt_pk_bf16_f32 v242, v244, v245
v_cvt_pk_bf16_f32 v243, v246, v247
v_xor_b32 v242, v17, v242
v_xor_b32 v243, v17, v243
ds_write_b64 v6, v[240:241] offset:1024
ds_write_b64 v7, v[242:243] offset:1024
L_b_s31:
s_setprio 0
s_sub_i32 s46, s46, 1
s_cmp_lt_i32 s46, 0
s_cbranch_scc1 L_bg3
buffer_load_dword v1, v12, s[40:43], s44 offen
s_add_u32 s44, s44, s45
L_bg3:
s_waitcnt lgkmcnt(0)
s_barrier
ds_read_b128 v[120:123], v11 offset:0
ds_read_b128 v[124:127], v11 offset:5120
ds_read_b128 v[128:131], v11 offset:10240
ds_read_b128 v[132:135], v11 offset:15360
ds_read_b128 v[136:139], v11 offset:20480
ds_read_b128 v[140:143], v11 offset:25600
ds_read_b128 v[144:147], v11 offset:30720
ds_read_b128 v[148:151], v11 offset:35840
ds_read_b128 v[152:155], v11 offset:1024
ds_read_b128 v[156:159], v11 offset:6144
ds_read_b128 v[160:163], v11 offset:11264
ds_read_b128 v[164:167], v11 offset:16384
ds_read_b128 v[168:171], v11 offset:21504
ds_read_b128 v[172:175], v11 offset:26624
ds_read_b128 v[176:179], v11 offset:31744
ds_read_b128 v[180:183], v11 offset:36864
s_cmp_eq_u32 s50, 0
s_cbranch_scc1 L_b_h11
s_waitcnt lgkmcnt(8)
v_mfma_f32_16x16x32_bf16 v[216:219], v[120:123], v[40:43], 0
ds_read_b128 v[184:187], v11 offset:2048
v_mfma_f32_16x16x32_bf16 v[220:223], v[124:127], v[40:43], 0
ds_read_b128 v[188:191], v11 offset:7168
v_mfma_f32_16x16x32_bf16 v[224:227], v[128:131], v[40:43], 0
ds_read_b128 v[192:195], v11 offset:12288
v_mfma_f32_16x16x32_bf16 v[228:231], v[132:135], v[40:43], 0
ds_read_b128 v[196:199], v11 offset:17408
v_mfma_f32_16x16x32_bf16 v[236:239], v[120:123], v[80:83], 0
ds_read_b128 v[200:203], v11 offset:22528
v_mfma_f32_16x16x32_bf16 v[240:243], v[124:127], v[80:83], 0
ds_read_b128 v[204:207], v11 offset:27648
v_mfma_f32_16x16x32_bf16 v[244:247], v[128:131], v[80:83], 0
ds_read_b128 v[208:211], v11 offset:32768
v_mfma_f32_16x16x32_bf16 v[248:251], v[132:135], v[80:83], 0
ds_read_b128 v[212:215], v11 offset:37888
v_mfma_f32_16x16x32_bf16 v[216:219], v[136:139], v[60:63], v[216:219]
v_mfma_f32_16x16x32_bf16 v[220:223], v[140:143], v[60:63], v[220:223]
v_mfma_f32_16x16x32_bf16 v[224:227], v[144:147], v[60:63], v[224:227]
v_mfma_f32_16x16x32_bf16 v[228:231], v[148:151], v[60:63], v[228:231]
v_mfma_f32_16x16x32_bf16 v[236:239], v[136:139], v[100:103], v[236:239]
v_mfma_f32_16x16x32_bf16 v[240:243], v[140:143], v[100:103], v[240:243]
v_mfma_f32_16x16x32_bf16 v[244:247], v[144:147], v[100:103], v[244:247]
v_mfma_f32_16x16x32_bf16 v[248:251], v[148:151], v[100:103], v[248:251]
s_waitcnt lgkmcnt(8)
v_mfma_f32_16x16x32_bf16 v[216:219], v[152:155], v[44:47], v[216:219]
ds_read_b128 v[120:123], v11 offset:3072
v_mfma_f32_16x16x32_bf16 v[220:223], v[156:159], v[44:47], v[220:223]
ds_read_b128 v[124:127], v11 offset:8192
v_mfma_f32_16x16x32_bf16 v[224:227], v[160:163], v[44:47], v[224:227]
ds_read_b128 v[128:131], v11 offset:13312
v_mfma_f32_16x16x32_bf16 v[228:231], v[164:167], v[44:47], v[228:231]
ds_read_b128 v[132:135], v11 offset:18432
v_mfma_f32_16x16x32_bf16 v[236:239], v[152:155], v[84:87], v[236:239]
ds_read_b128 v[136:139], v11 offset:23552
v_mfma_f32_16x16x32_bf16 v[240:243], v[156:159], v[84:87], v[240:243]
ds_read_b128 v[140:143], v11 offset:28672
v_mfma_f32_16x16x32_bf16 v[244:247], v[160:163], v[84:87], v[244:247]
ds_read_b128 v[144:147], v11 offset:33792
v_mfma_f32_16x16x32_bf16 v[248:251], v[164:167], v[84:87], v[248:251]
ds_read_b128 v[148:151], v11 offset:38912
v_mfma_f32_16x16x32_bf16 v[216:219], v[168:171], v[64:67], v[216:219]
v_mfma_f32_16x16x32_bf16 v[220:223], v[172:175], v[64:67], v[220:223]
v_mfma_f32_16x16x32_bf16 v[224:227], v[176:179], v[64:67], v[224:227]
v_mfma_f32_16x16x32_bf16 v[228:231], v[180:183], v[64:67], v[228:231]
v_mfma_f32_16x16x32_bf16 v[236:239], v[168:171], v[104:107], v[236:239]
v_mfma_f32_16x16x32_bf16 v[240:243], v[172:175], v[104:107], v[240:243]
v_mfma_f32_16x16x32_bf16 v[244:247], v[176:179], v[104:107], v[244:247]
v_mfma_f32_16x16x32_bf16 v[248:251], v[180:183], v[104:107], v[248:251]
s_waitcnt lgkmcnt(8)
v_mfma_f32_16x16x32_bf16 v[216:219], v[184:187], v[48:51], v[216:219]
ds_read_b128 v[152:155], v11 offset:4096
v_mfma_f32_16x16x32_bf16 v[220:223], v[188:191], v[48:51], v[220:223]
ds_read_b128 v[156:159], v11 offset:9216
v_mfma_f32_16x16x32_bf16 v[224:227], v[192:195], v[48:51], v[224:227]
ds_read_b128 v[160:163], v11 offset:14336
v_mfma_f32_16x16x32_bf16 v[228:231], v[196:199], v[48:51], v[228:231]
ds_read_b128 v[164:167], v11 offset:19456
v_mfma_f32_16x16x32_bf16 v[236:239], v[184:187], v[88:91], v[236:239]
ds_read_b128 v[168:171], v11 offset:24576
v_mfma_f32_16x16x32_bf16 v[240:243], v[188:191], v[88:91], v[240:243]
ds_read_b128 v[172:175], v11 offset:29696
v_mfma_f32_16x16x32_bf16 v[244:247], v[192:195], v[88:91], v[244:247]
ds_read_b128 v[176:179], v11 offset:34816
v_mfma_f32_16x16x32_bf16 v[248:251], v[196:199], v[88:91], v[248:251]
ds_read_b128 v[180:183], v11 offset:39936
v_mfma_f32_16x16x32_bf16 v[216:219], v[200:203], v[68:71], v[216:219]
v_mfma_f32_16x16x32_bf16 v[220:223], v[204:207], v[68:71], v[220:223]
v_mfma_f32_16x16x32_bf16 v[224:227], v[208:211], v[68:71], v[224:227]
v_mfma_f32_16x16x32_bf16 v[228:231], v[212:215], v[68:71], v[228:231]
v_mfma_f32_16x16x32_bf16 v[236:239], v[200:203], v[108:111], v[236:239]
v_mfma_f32_16x16x32_bf16 v[240:243], v[204:207], v[108:111], v[240:243]
v_mfma_f32_16x16x32_bf16 v[244:247], v[208:211], v[108:111], v[244:247]
v_mfma_f32_16x16x32_bf16 v[248:251], v[212:215], v[108:111], v[248:251]
s_waitcnt lgkmcnt(8)
v_mfma_f32_16x16x32_bf16 v[216:219], v[120:123], v[52:55], v[216:219]
v_mfma_f32_16x16x32_bf16 v[220:223], v[124:127], v[52:55], v[220:223]
v_mfma_f32_16x16x32_bf16 v[224:227], v[128:131], v[52:55], v[224:227]
v_mfma_f32_16x16x32_bf16 v[228:231], v[132:135], v[52:55], v[228:231]
v_mfma_f32_16x16x32_bf16 v[236:239], v[120:123], v[92:95], v[236:239]
v_mfma_f32_16x16x32_bf16 v[240:243], v[124:127], v[92:95], v[240:243]
v_mfma_f32_16x16x32_bf16 v[244:247], v[128:131], v[92:95], v[244:247]
v_mfma_f32_16x16x32_bf16 v[248:251], v[132:135], v[92:95], v[248:251]
v_mfma_f32_16x16x32_bf16 v[216:219], v[136:139], v[72:75], v[216:219]
v_mfma_f32_16x16x32_bf16 v[220:223], v[140:143], v[72:75], v[220:223]
v_mfma_f32_16x16x32_bf16 v[224:227], v[144:147], v[72:75], v[224:227]
v_mfma_f32_16x16x32_bf16 v[228:231], v[148:151], v[72:75], v[228:231]
v_mfma_f32_16x16x32_bf16 v[236:239], v[136:139], v[112:115], v[236:239]
v_mfma_f32_16x16x32_bf16 v[240:243], v[140:143], v[112:115], v[240:243]
v_mfma_f32_16x16x32_bf16 v[244:247], v[144:147], v[112:115], v[244:247]
v_mfma_f32_16x16x32_bf16 v[248:251], v[148:151], v[112:115], v[248:251]
s_waitcnt lgkmcnt(0)
v_mfma_f32_16x16x32_bf16 v[216:219], v[152:155], v[56:59], v[216:219]
v_mfma_f32_16x16x32_bf16 v[220:223], v[156:159], v[56:59], v[220:223]
v_mfma_f32_16x16x32_bf16 v[224:227], v[160:163], v[56:59], v[224:227]
v_mfma_f32_16x16x32_bf16 v[228:231], v[164:167], v[56:59], v[228:231]
v_mfma_f32_16x16x32_bf16 v[236:239], v[152:155], v[96:99], v[236:239]
v_mfma_f32_16x16x32_bf16 v[240:243], v[156:159], v[96:99], v[240:243]
v_mfma_f32_16x16x32_bf16 v[244:247], v[160:163], v[96:99], v[244:247]
v_mfma_f32_16x16x32_bf16 v[248:251], v[164:167], v[96:99], v[248:251]
v_mfma_f32_16x16x32_bf16 v[216:219], v[168:171], v[76:79], v[216:219]
v_mfma_f32_16x16x32_bf16 v[220:223], v[172:175], v[76:79], v[220:223]
v_mfma_f32_16x16x32_bf16 v[224:227], v[176:179], v[76:79], v[224:227]
v_mfma_f32_16x16x32_bf16 v[228:231], v[180:183], v[76:79], v[228:231]
v_mfma_f32_16x16x32_bf16 v[236:239], v[168:171], v[116:119], v[236:239]
v_mfma_f32_16x16x32_bf16 v[240:243], v[172:175], v[116:119], v[240:243]
v_mfma_f32_16x16x32_bf16 v[244:247], v[176:179], v[116:119], v[244:247]
v_mfma_f32_16x16x32_bf16 v[248:251], v[180:183], v[116:119], v[248:251]
s_add_u32 s27, s48, 0
s_lshl_b32 s27, s27, 4
v_add_u32 v7, s27, v13
v_mul_u32_u24 v6, 3277, v7
v_lshrrev_b32 v6, 16, v6
v_mul_u32_u24 v2, 20, v6
v_sub_u32 v7, v7, v2
v_mul_u32_u24 v2, 80, v6
v_lshl_add_u32 v2, v7, 2, v2
v_add_u32 v2, 122880, v2
v_sub_f32 v120, v216, v220
v_sub_f32 v121, v217, v221
v_sub_f32 v122, v218, v222
v_sub_f32 v123, v219, v223
v_add_f32 v128, v216, v220
v_add_f32 v129, v217, v221
v_add_f32 v130, v218, v222
v_add_f32 v131, v219, v223
v_add_f32 v124, v228, v224
v_add_f32 v125, v229, v225
v_add_f32 v126, v230, v226
v_add_f32 v127, v231, v227
v_sub_f32 v132, v228, v224
v_sub_f32 v133, v229, v225
v_sub_f32 v134, v230, v226
v_sub_f32 v135, v231, v227
v_cndmask_b32 v120, v120, v216, s[54:55]
v_cndmask_b32 v124, v124, v228, s[54:55]
v_cndmask_b32 v128, v128, v224, s[54:55]
v_cndmask_b32 v132, v132, v220, s[54:55]
v_cvt_pk_bf16_f32 v136, v120, v124
v_cvt_pk_bf16_f32 v140, v128, v132
v_cvt_pk_bf16_f32 v137, v121, v125
v_cvt_pk_bf16_f32 v141, v129, v133
v_cvt_pk_bf16_f32 v138, v122, v126
v_cvt_pk_bf16_f32 v142, v130, v134
v_cvt_pk_bf16_f32 v139, v123, v127
v_cvt_pk_bf16_f32 v143, v131, v135
v_add_u32 v3, v2, v8
v_add_u32 v4, v2, v9
v_add_u32 v5, v2, v10
ds_write_b32 v3, v136 offset:0
ds_write_b32 v5, v140 offset:1920
ds_write_b32 v3, v137 offset:640
ds_write_b32 v4, v141 offset:1280
ds_write_b32 v3, v138 offset:1280
ds_write_b32 v4, v142 offset:640
ds_write_b32 v3, v139 offset:1920
ds_write_b32 v4, v143 offset:0
s_add_u32 s27, s48, 1
s_lshl_b32 s27, s27, 4
v_add_u32 v7, s27, v13
v_mul_u32_u24 v6, 3277, v7
v_lshrrev_b32 v6, 16, v6
v_mul_u32_u24 v2, 20, v6
v_sub_u32 v7, v7, v2
v_mul_u32_u24 v2, 80, v6
v_lshl_add_u32 v2, v7, 2, v2
v_add_u32 v2, 122880, v2
v_sub_f32 v120, v236, v240
v_sub_f32 v121, v237, v241
v_sub_f32 v122, v238, v242
v_sub_f32 v123, v239, v243
v_add_f32 v128, v236, v240
v_add_f32 v129, v237, v241
v_add_f32 v130, v238, v242
v_add_f32 v131, v239, v243
v_add_f32 v124, v248, v244
v_add_f32 v125, v249, v245
v_add_f32 v126, v250, v246
v_add_f32 v127, v251, v247
v_sub_f32 v132, v248, v244
v_sub_f32 v133, v249, v245
v_sub_f32 v134, v250, v246
v_sub_f32 v135, v251, v247
v_cndmask_b32 v120, v120, v236, s[54:55]
v_cndmask_b32 v124, v124, v248, s[54:55]
v_cndmask_b32 v128, v128, v244, s[54:55]
v_cndmask_b32 v132, v132, v240, s[54:55]
v_cvt_pk_bf16_f32 v136, v120, v124
v_cvt_pk_bf16_f32 v140, v128, v132
v_cvt_pk_bf16_f32 v137, v121, v125
v_cvt_pk_bf16_f32 v141, v129, v133
v_cvt_pk_bf16_f32 v138, v122, v126
v_cvt_pk_bf16_f32 v142, v130, v134
v_cvt_pk_bf16_f32 v139, v123, v127
v_cvt_pk_bf16_f32 v143, v131, v135
v_add_u32 v3, v2, v8
v_add_u32 v4, v2, v9
v_add_u32 v5, v2, v10
ds_write_b32 v3, v136 offset:0
ds_write_b32 v5, v140 offset:1920
ds_write_b32 v3, v137 offset:640
ds_write_b32 v4, v141 offset:1280
ds_write_b32 v3, v138 offset:1280
ds_write_b32 v4, v142 offset:640
ds_write_b32 v3, v139 offset:1920
ds_write_b32 v4, v143 offset:0
s_branch L_b_end
L_b_h11:
s_waitcnt lgkmcnt(8)
v_mfma_f32_16x16x32_bf16 v[216:219], v[120:123], v[40:43], 0
ds_read_b128 v[184:187], v11 offset:2048
v_mfma_f32_16x16x32_bf16 v[220:223], v[124:127], v[40:43], 0
ds_read_b128 v[188:191], v11 offset:7168
v_mfma_f32_16x16x32_bf16 v[224:227], v[128:131], v[40:43], 0
ds_read_b128 v[192:195], v11 offset:12288
v_mfma_f32_16x16x32_bf16 v[228:231], v[132:135], v[40:43], 0
ds_read_b128 v[196:199], v11 offset:17408
v_mfma_f32_16x16x32_bf16 v[216:219], v[136:139], v[60:63], v[216:219]
ds_read_b128 v[200:203], v11 offset:22528
v_mfma_f32_16x16x32_bf16 v[220:223], v[140:143], v[60:63], v[220:223]
ds_read_b128 v[204:207], v11 offset:27648
v_mfma_f32_16x16x32_bf16 v[224:227], v[144:147], v[60:63], v[224:227]
ds_read_b128 v[208:211], v11 offset:32768
v_mfma_f32_16x16x32_bf16 v[228:231], v[148:151], v[60:63], v[228:231]
ds_read_b128 v[212:215], v11 offset:37888
s_waitcnt lgkmcnt(8)
v_mfma_f32_16x16x32_bf16 v[216:219], v[152:155], v[44:47], v[216:219]
ds_read_b128 v[120:123], v11 offset:3072
v_mfma_f32_16x16x32_bf16 v[220:223], v[156:159], v[44:47], v[220:223]
ds_read_b128 v[124:127], v11 offset:8192
v_mfma_f32_16x16x32_bf16 v[224:227], v[160:163], v[44:47], v[224:227]
ds_read_b128 v[128:131], v11 offset:13312
v_mfma_f32_16x16x32_bf16 v[228:231], v[164:167], v[44:47], v[228:231]
ds_read_b128 v[132:135], v11 offset:18432
v_mfma_f32_16x16x32_bf16 v[216:219], v[168:171], v[64:67], v[216:219]
ds_read_b128 v[136:139], v11 offset:23552
v_mfma_f32_16x16x32_bf16 v[220:223], v[172:175], v[64:67], v[220:223]
ds_read_b128 v[140:143], v11 offset:28672
v_mfma_f32_16x16x32_bf16 v[224:227], v[176:179], v[64:67], v[224:227]
ds_read_b128 v[144:147], v11 offset:33792
v_mfma_f32_16x16x32_bf16 v[228:231], v[180:183], v[64:67], v[228:231]
ds_read_b128 v[148:151], v11 offset:38912
s_waitcnt lgkmcnt(8)
v_mfma_f32_16x16x32_bf16 v[216:219], v[184:187], v[48:51], v[216:219]
ds_read_b128 v[152:155], v11 offset:4096
v_mfma_f32_16x16x32_bf16 v[220:223], v[188:191], v[48:51], v[220:223]
ds_read_b128 v[156:159], v11 offset:9216
v_mfma_f32_16x16x32_bf16 v[224:227], v[192:195], v[48:51], v[224:227]
ds_read_b128 v[160:163], v11 offset:14336
v_mfma_f32_16x16x32_bf16 v[228:231], v[196:199], v[48:51], v[228:231]
ds_read_b128 v[164:167], v11 offset:19456
v_mfma_f32_16x16x32_bf16 v[216:219], v[200:203], v[68:71], v[216:219]
ds_read_b128 v[168:171], v11 offset:24576
v_mfma_f32_16x16x32_bf16 v[220:223], v[204:207], v[68:71], v[220:223]
ds_read_b128 v[172:175], v11 offset:29696
v_mfma_f32_16x16x32_bf16 v[224:227], v[208:211], v[68:71], v[224:227]
ds_read_b128 v[176:179], v11 offset:34816
v_mfma_f32_16x16x32_bf16 v[228:231], v[212:215], v[68:71], v[228:231]
ds_read_b128 v[180:183], v11 offset:39936
s_waitcnt lgkmcnt(8)
v_mfma_f32_16x16x32_bf16 v[216:219], v[120:123], v[52:55], v[216:219]
v_mfma_f32_16x16x32_bf16 v[220:223], v[124:127], v[52:55], v[220:223]
v_mfma_f32_16x16x32_bf16 v[224:227], v[128:131], v[52:55], v[224:227]
v_mfma_f32_16x16x32_bf16 v[228:231], v[132:135], v[52:55], v[228:231]
v_mfma_f32_16x16x32_bf16 v[216:219], v[136:139], v[72:75], v[216:219]
v_mfma_f32_16x16x32_bf16 v[220:223], v[140:143], v[72:75], v[220:223]
v_mfma_f32_16x16x32_bf16 v[224:227], v[144:147], v[72:75], v[224:227]
v_mfma_f32_16x16x32_bf16 v[228:231], v[148:151], v[72:75], v[228:231]
s_waitcnt lgkmcnt(0)
v_mfma_f32_16x16x32_bf16 v[216:219], v[152:155], v[56:59], v[216:219]
v_mfma_f32_16x16x32_bf16 v[220:223], v[156:159], v[56:59], v[220:223]
v_mfma_f32_16x16x32_bf16 v[224:227], v[160:163], v[56:59], v[224:227]
v_mfma_f32_16x16x32_bf16 v[228:231], v[164:167], v[56:59], v[228:231]
v_mfma_f32_16x16x32_bf16 v[216:219], v[168:171], v[76:79], v[216:219]
v_mfma_f32_16x16x32_bf16 v[220:223], v[172:175], v[76:79], v[220:223]
v_mfma_f32_16x16x32_bf16 v[224:227], v[176:179], v[76:79], v[224:227]
v_mfma_f32_16x16x32_bf16 v[228:231], v[180:183], v[76:79], v[228:231]
s_add_u32 s27, s48, 0
s_lshl_b32 s27, s27, 4
v_add_u32 v7, s27, v13
v_mul_u32_u24 v6, 3277, v7
v_lshrrev_b32 v6, 16, v6
v_mul_u32_u24 v2, 20, v6
v_sub_u32 v7, v7, v2
v_mul_u32_u24 v2, 80, v6
v_lshl_add_u32 v2, v7, 2, v2
v_add_u32 v2, 122880, v2
v_sub_f32 v120, v216, v220
v_sub_f32 v121, v217, v221
v_sub_f32 v122, v218, v222
v_sub_f32 v123, v219, v223
v_add_f32 v128, v216, v220
v_add_f32 v129, v217, v221
v_add_f32 v130, v218, v222
v_add_f32 v131, v219, v223
v_add_f32 v124, v228, v224
v_add_f32 v125, v229, v225
v_add_f32 v126, v230, v226
v_add_f32 v127, v231, v227
v_sub_f32 v132, v228, v224
v_sub_f32 v133, v229, v225
v_sub_f32 v134, v230, v226
v_sub_f32 v135, v231, v227
v_cndmask_b32 v120, v120, v216, s[54:55]
v_cndmask_b32 v124, v124, v228, s[54:55]
v_cndmask_b32 v128, v128, v224, s[54:55]
v_cndmask_b32 v132, v132, v220, s[54:55]
v_cvt_pk_bf16_f32 v136, v120, v124
v_cvt_pk_bf16_f32 v140, v128, v132
v_cvt_pk_bf16_f32 v137, v121, v125
v_cvt_pk_bf16_f32 v141, v129, v133
v_cvt_pk_bf16_f32 v138, v122, v126
v_cvt_pk_bf16_f32 v142, v130, v134
v_cvt_pk_bf16_f32 v139, v123, v127
v_cvt_pk_bf16_f32 v143, v131, v135
v_add_u32 v3, v2, v8
v_add_u32 v4, v2, v9
v_add_u32 v5, v2, v10
ds_write_b32 v3, v136 offset:0
ds_write_b32 v5, v140 offset:1920
ds_write_b32 v3, v137 offset:640
ds_write_b32 v4, v141 offset:1280
ds_write_b32 v3, v138 offset:1280
ds_write_b32 v4, v142 offset:640
ds_write_b32 v3, v139 offset:1920
ds_write_b32 v4, v143 offset:0
s_branch L_b_end
L_b_ev:
s_cmp_eq_u32 s25, 0
s_cbranch_scc1 L_b_s20
v_mfma_f32_16x16x32_bf16 v[232:235], v[184:187], v[120:123], 0
ds_read_b64_tr_b16 v[152:153], v2 offset:8192
ds_read_b64_tr_b16 v[154:155], v2 offset:9216
v_mfma_f32_16x16x32_bf16 v[240:243], v[184:187], v[136:139], 0
ds_read_b64_tr_b16 v[156:157], v2 offset:12288
ds_read_b64_tr_b16 v[158:159], v2 offset:13312
v_mfma_f32_16x16x32_bf16 v[236:239], v[192:195], v[128:131], 0
ds_read_b64_tr_b16 v[160:161], v3 offset:24576
ds_read_b64_tr_b16 v[162:163], v3 offset:25600
v_mfma_f32_16x16x32_bf16 v[244:247], v[192:195], v[136:139], 0
ds_read_b64_tr_b16 v[164:165], v3 offset:28672
ds_read_b64_tr_b16 v[166:167], v3 offset:29696
v_mfma_f32_16x16x32_bf16 v[232:235], v[188:191], v[124:127], v[232:235]
ds_read_b64_tr_b16 v[168:169], v4 offset:8192
ds_read_b64_tr_b16 v[170:171], v4 offset:9216
v_mfma_f32_16x16x32_bf16 v[240:243], v[188:191], v[140:143], v[240:243]
ds_read_b64_tr_b16 v[172:173], v4 offset:12288
ds_read_b64_tr_b16 v[174:175], v4 offset:13312
v_mfma_f32_16x16x32_bf16 v[236:239], v[196:199], v[132:135], v[236:239]
ds_read_b64_tr_b16 v[176:177], v5 offset:24576
ds_read_b64_tr_b16 v[178:179], v5 offset:25600
v_mfma_f32_16x16x32_bf16 v[244:247], v[196:199], v[140:143], v[244:247]
ds_read_b64_tr_b16 v[180:181], v5 offset:28672
ds_read_b64_tr_b16 v[182:183], v5 offset:29696
v_mfma_f32_16x16x32_bf16 v[232:235], v[200:203], v[128:131], v[232:235]
v_add_f32 v252, v216, v220
v_add_f32 v253, v217, v221
v_mfma_f32_16x16x32_bf16 v[240:243], v[200:203], v[144:147], v[240:243]
v_add_f32 v254, v218, v222
v_add_f32 v255, v219, v223
v_mfma_f32_16x16x32_bf16 v[236:239], v[208:211], v[120:123], v[236:239]
v_sub_f32 v220, v216, v220
v_sub_f32 v221, v217, v221
v_mfma_f32_16x16x32_bf16 v[244:247], v[208:211], v[144:147], v[244:247]
v_sub_f32 v222, v218, v222
v_sub_f32 v223, v219, v223
v_mfma_f32_16x16x32_bf16 v[232:235], v[204:207], v[132:135], v[232:235]
v_cvt_pk_bf16_f32 v216, v252, v253
v_cvt_pk_bf16_f32 v217, v254, v255
v_mfma_f32_16x16x32_bf16 v[240:243], v[204:207], v[148:151], v[240:243]
v_cvt_pk_bf16_f32 v218, v220, v221
v_cvt_pk_bf16_f32 v219, v222, v223
v_mfma_f32_16x16x32_bf16 v[236:239], v[212:215], v[124:127], v[236:239]
ds_write_b64 v16, v[216:217] offset:0
ds_write_b64 v16, v[218:219] offset:20480
v_mfma_f32_16x16x32_bf16 v[244:247], v[212:215], v[148:151], v[244:247]
v_add_f32 v252, v224, v228
v_add_f32 v253, v225, v229
v_add_f32 v254, v226, v230
v_add_f32 v255, v227, v231
v_sub_f32 v228, v224, v228
v_sub_f32 v229, v225, v229
v_sub_f32 v230, v226, v230
v_sub_f32 v231, v227, v231
v_cvt_pk_bf16_f32 v224, v252, v253
v_cvt_pk_bf16_f32 v225, v254, v255
v_cvt_pk_bf16_f32 v226, v228, v229
v_cvt_pk_bf16_f32 v227, v230, v231
ds_write_b64 v6, v[224:225] offset:0
ds_write_b64 v7, v[226:227] offset:0
s_waitcnt lgkmcnt(4)
v_mfma_f32_16x16x32_bf16 v[216:219], v[152:155], v[120:123], 0
v_mfma_f32_16x16x32_bf16 v[224:227], v[152:155], v[136:139], 0
v_mfma_f32_16x16x32_bf16 v[220:223], v[160:163], v[128:131], 0
v_mfma_f32_16x16x32_bf16 v[228:231], v[160:163], v[136:139], 0
v_add_f32 v252, v232, v236
v_add_f32 v253, v233, v237
v_mfma_f32_16x16x32_bf16 v[216:219], v[156:159], v[124:127], v[216:219]
v_add_f32 v254, v234, v238
v_add_f32 v255, v235, v239
v_mfma_f32_16x16x32_bf16 v[224:227], v[156:159], v[140:143], v[224:227]
v_sub_f32 v236, v232, v236
v_sub_f32 v237, v233, v237
v_mfma_f32_16x16x32_bf16 v[220:223], v[164:167], v[132:135], v[220:223]
v_sub_f32 v238, v234, v238
v_sub_f32 v239, v235, v239
v_mfma_f32_16x16x32_bf16 v[228:231], v[164:167], v[140:143], v[228:231]
v_cvt_pk_bf16_f32 v232, v252, v253
v_cvt_pk_bf16_f32 v233, v254, v255
v_mfma_f32_16x16x32_bf16 v[216:219], v[168:171], v[128:131], v[216:219]
v_cvt_pk_bf16_f32 v234, v236, v237
v_cvt_pk_bf16_f32 v235, v238, v239
v_mfma_f32_16x16x32_bf16 v[224:227], v[168:171], v[144:147], v[224:227]
ds_write_b64 v16, v[232:233] offset:1024
ds_write_b64 v16, v[234:235] offset:21504
v_mfma_f32_16x16x32_bf16 v[220:223], v[176:179], v[120:123], v[220:223]
v_add_f32 v252, v240, v244
v_add_f32 v253, v241, v245
v_mfma_f32_16x16x32_bf16 v[228:231], v[176:179], v[144:147], v[228:231]
v_add_f32 v254, v242, v246
v_add_f32 v255, v243, v247
v_mfma_f32_16x16x32_bf16 v[216:219], v[172:175], v[132:135], v[216:219]
v_sub_f32 v244, v240, v244
v_sub_f32 v245, v241, v245
v_mfma_f32_16x16x32_bf16 v[224:227], v[172:175], v[148:151], v[224:227]
v_sub_f32 v246, v242, v246
v_sub_f32 v247, v243, v247
v_mfma_f32_16x16x32_bf16 v[220:223], v[180:183], v[124:127], v[220:223]
v_cvt_pk_bf16_f32 v240, v252, v253
v_cvt_pk_bf16_f32 v241, v254, v255
v_mfma_f32_16x16x32_bf16 v[228:231], v[180:183], v[148:151], v[228:231]
v_cvt_pk_bf16_f32 v242, v244, v245
v_cvt_pk_bf16_f32 v243, v246, v247
ds_write_b64 v6, v[240:241] offset:1024
ds_write_b64 v7, v[242:243] offset:1024
s_nop 0
v_add_f32 v252, v216, v220
v_add_f32 v253, v217, v221
v_add_f32 v254, v218, v222
v_add_f32 v255, v219, v223
v_sub_f32 v220, v216, v220
v_sub_f32 v221, v217, v221
v_sub_f32 v222, v218, v222
v_sub_f32 v223, v219, v223
v_cvt_pk_bf16_f32 v216, v252, v253
v_cvt_pk_bf16_f32 v217, v254, v255
v_cvt_pk_bf16_f32 v218, v220, v221
v_cvt_pk_bf16_f32 v219, v222, v223
ds_write_b64 v16, v[216:217] offset:2048
ds_write_b64 v16, v[218:219] offset:22528
v_add_f32 v252, v224, v228
v_add_f32 v253, v225, v229
v_add_f32 v254, v226, v230
v_add_f32 v255, v227, v231
v_sub_f32 v228, v224, v228
v_sub_f32 v229, v225, v229
v_sub_f32 v230, v226, v230
v_sub_f32 v231, v227, v231
v_cvt_pk_bf16_f32 v224, v252, v253
v_cvt_pk_bf16_f32 v225, v254, v255
v_cvt_pk_bf16_f32 v226, v228, v229
v_cvt_pk_bf16_f32 v227, v230, v231
ds_write_b64 v6, v[224:225] offset:2048
ds_write_b64 v7, v[226:227] offset:2048
s_branch L_b_s30
L_b_s20:
s_nop 3
v_mfma_f32_16x16x32_bf16 v[232:235], v[184:187], v[120:123], 0
v_mfma_f32_16x16x32_bf16 v[240:243], v[184:187], v[136:139], 0
v_mfma_f32_16x16x32_bf16 v[236:239], v[192:195], v[128:131], 0
v_mfma_f32_16x16x32_bf16 v[244:247], v[192:195], v[136:139], 0
v_add_f32 v252, v216, v220
v_add_f32 v253, v217, v221
v_mfma_f32_16x16x32_bf16 v[232:235], v[188:191], v[124:127], v[232:235]
v_add_f32 v254, v218, v222
v_add_f32 v255, v219, v223
v_mfma_f32_16x16x32_bf16 v[240:243], v[188:191], v[140:143], v[240:243]
v_sub_f32 v220, v216, v220
v_sub_f32 v221, v217, v221
v_mfma_f32_16x16x32_bf16 v[236:239], v[196:199], v[132:135], v[236:239]
v_sub_f32 v222, v218, v222
v_sub_f32 v223, v219, v223
v_mfma_f32_16x16x32_bf16 v[244:247], v[196:199], v[140:143], v[244:247]
v_cvt_pk_bf16_f32 v216, v252, v253
v_cvt_pk_bf16_f32 v217, v254, v255
v_mfma_f32_16x16x32_bf16 v[232:235], v[200:203], v[128:131], v[232:235]
v_cvt_pk_bf16_f32 v218, v220, v221
v_cvt_pk_bf16_f32 v219, v222, v223
v_mfma_f32_16x16x32_bf16 v[240:243], v[200:203], v[144:147], v[240:243]
ds_write_b64 v16, v[216:217] offset:0
ds_write_b64 v16, v[218:219] offset:20480
v_mfma_f32_16x16x32_bf16 v[236:239], v[208:211], v[120:123], v[236:239]
v_add_f32 v252, v224, v228
v_add_f32 v253, v225, v229
v_mfma_f32_16x16x32_bf16 v[244:247], v[208:211], v[144:147], v[244:247]
v_add_f32 v254, v226, v230
v_add_f32 v255, v227, v231
v_mfma_f32_16x16x32_bf16 v[232:235], v[204:207], v[132:135], v[232:235]
v_sub_f32 v228, v224, v228
v_sub_f32 v229, v225, v229
v_mfma_f32_16x16x32_bf16 v[240:243], v[204:207], v[148:151], v[240:243]
v_sub_f32 v230, v226, v230
v_sub_f32 v231, v227, v231
v_mfma_f32_16x16x32_bf16 v[236:239], v[212:215], v[124:127], v[236:239]
v_cvt_pk_bf16_f32 v224, v252, v253
v_cvt_pk_bf16_f32 v225, v254, v255
v_mfma_f32_16x16x32_bf16 v[244:247], v[212:215], v[148:151], v[244:247]
v_cvt_pk_bf16_f32 v226, v228, v229
v_cvt_pk_bf16_f32 v227, v230, v231
ds_write_b64 v6, v[224:225] offset:0
ds_write_b64 v7, v[226:227] offset:0
s_nop 0
v_add_f32 v252, v232, v236
v_add_f32 v253, v233, v237
v_add_f32 v254, v234, v238
v_add_f32 v255, v235, v239
v_sub_f32 v236, v232, v236
v_sub_f32 v237, v233, v237
v_sub_f32 v238, v234, v238
v_sub_f32 v239, v235, v239
v_cvt_pk_bf16_f32 v232, v252, v253
v_cvt_pk_bf16_f32 v233, v254, v255
v_cvt_pk_bf16_f32 v234, v236, v237
v_cvt_pk_bf16_f32 v235, v238, v239
ds_write_b64 v16, v[232:233] offset:1024
ds_write_b64 v16, v[234:235] offset:21504
v_add_f32 v252, v240, v244
v_add_f32 v253, v241, v245
v_add_f32 v254, v242, v246
v_add_f32 v255, v243, v247
v_sub_f32 v244, v240, v244
v_sub_f32 v245, v241, v245
v_sub_f32 v246, v242, v246
v_sub_f32 v247, v243, v247
v_cvt_pk_bf16_f32 v240, v252, v253
v_cvt_pk_bf16_f32 v241, v254, v255
v_cvt_pk_bf16_f32 v242, v244, v245
v_cvt_pk_bf16_f32 v243, v246, v247
ds_write_b64 v6, v[240:241] offset:1024
ds_write_b64 v7, v[242:243] offset:1024
L_b_s30:
s_setprio 0
s_sub_i32 s46, s46, 1
s_cmp_lt_i32 s46, 0
s_cbranch_scc1 L_bg4
buffer_load_dword v1, v12, s[40:43], s44 offen
s_add_u32 s44, s44, s45
L_bg4:
s_waitcnt lgkmcnt(0)
s_barrier
ds_read_b128 v[120:123], v11 offset:0
ds_read_b128 v[124:127], v11 offset:5120
ds_read_b128 v[128:131], v11 offset:10240
ds_read_b128 v[132:135], v11 offset:15360
ds_read_b128 v[152:155], v11 offset:1024
ds_read_b128 v[156:159], v11 offset:6144
ds_read_b128 v[160:163], v11 offset:11264
ds_read_b128 v[164:167], v11 offset:16384
s_cmp_eq_u32 s50, 0
s_cbranch_scc1 L_b_h10
s_waitcnt lgkmcnt(4)
v_mfma_f32_16x16x32_bf16 v[216:219], v[120:123], v[40:43], 0
ds_read_b128 v[184:187], v11 offset:2048
v_mfma_f32_16x16x32_bf16 v[220:223], v[124:127], v[60:63], 0
ds_read_b128 v[188:191], v11 offset:7168
v_mfma_f32_16x16x32_bf16 v[224:227], v[128:131], v[40:43], 0
ds_read_b128 v[192:195], v11 offset:12288
v_mfma_f32_16x16x32_bf16 v[228:231], v[132:135], v[60:63], 0
ds_read_b128 v[196:199], v11 offset:17408
v_mfma_f32_16x16x32_bf16 v[232:235], v[132:135], v[40:43], 0
v_mfma_f32_16x16x32_bf16 v[236:239], v[120:123], v[80:83], 0
v_mfma_f32_16x16x32_bf16 v[240:243], v[124:127], v[100:103], 0
v_mfma_f32_16x16x32_bf16 v[244:247], v[128:131], v[80:83], 0
v_mfma_f32_16x16x32_bf16 v[248:251], v[132:135], v[100:103], 0
v_mfma_f32_16x16x32_bf16 v[252:255], v[132:135], v[80:83], 0
s_waitcnt lgkmcnt(4)
v_mfma_f32_16x16x32_bf16 v[216:219], v[152:155], v[44:47], v[216:219]
ds_read_b128 v[120:123], v11 offset:3072
v_mfma_f32_16x16x32_bf16 v[220:223], v[156:159], v[64:67], v[220:223]
ds_read_b128 v[124:127], v11 offset:8192
v_mfma_f32_16x16x32_bf16 v[224:227], v[160:163], v[44:47], v[224:227]
ds_read_b128 v[128:131], v11 offset:13312
v_mfma_f32_16x16x32_bf16 v[228:231], v[164:167], v[64:67], v[228:231]
ds_read_b128 v[132:135], v11 offset:18432
v_mfma_f32_16x16x32_bf16 v[232:235], v[164:167], v[44:47], v[232:235]
v_mfma_f32_16x16x32_bf16 v[236:239], v[152:155], v[84:87], v[236:239]
v_mfma_f32_16x16x32_bf16 v[240:243], v[156:159], v[104:107], v[240:243]
v_mfma_f32_16x16x32_bf16 v[244:247], v[160:163], v[84:87], v[244:247]
v_mfma_f32_16x16x32_bf16 v[248:251], v[164:167], v[104:107], v[248:251]
v_mfma_f32_16x16x32_bf16 v[252:255], v[164:167], v[84:87], v[252:255]
s_waitcnt lgkmcnt(4)
v_mfma_f32_16x16x32_bf16 v[216:219], v[184:187], v[48:51], v[216:219]
ds_read_b128 v[152:155], v11 offset:4096
v_mfma_f32_16x16x32_bf16 v[220:223], v[188:191], v[68:71], v[220:223]
ds_read_b128 v[156:159], v11 offset:9216
v_mfma_f32_16x16x32_bf16 v[224:227], v[192:195], v[48:51], v[224:227]
ds_read_b128 v[160:163], v11 offset:14336
v_mfma_f32_16x16x32_bf16 v[228:231], v[196:199], v[68:71], v[228:231]
ds_read_b128 v[164:167], v11 offset:19456
v_mfma_f32_16x16x32_bf16 v[232:235], v[196:199], v[48:51], v[232:235]
v_mfma_f32_16x16x32_bf16 v[236:239], v[184:187], v[88:91], v[236:239]
v_mfma_f32_16x16x32_bf16 v[240:243], v[188:191], v[108:111], v[240:243]
v_mfma_f32_16x16x32_bf16 v[244:247], v[192:195], v[88:91], v[244:247]
v_mfma_f32_16x16x32_bf16 v[248:251], v[196:199], v[108:111], v[248:251]
v_mfma_f32_16x16x32_bf16 v[252:255], v[196:199], v[88:91], v[252:255]
s_waitcnt lgkmcnt(4)
v_mfma_f32_16x16x32_bf16 v[216:219], v[120:123], v[52:55], v[216:219]
v_mfma_f32_16x16x32_bf16 v[220:223], v[124:127], v[72:75], v[220:223]
v_mfma_f32_16x16x32_bf16 v[224:227], v[128:131], v[52:55], v[224:227]
v_mfma_f32_16x16x32_bf16 v[228:231], v[132:135], v[72:75], v[228:231]
v_mfma_f32_16x16x32_bf16 v[232:235], v[132:135], v[52:55], v[232:235]
v_mfma_f32_16x16x32_bf16 v[236:239], v[120:123], v[92:95], v[236:239]
v_mfma_f32_16x16x32_bf16 v[240:243], v[124:127], v[112:115], v[240:243]
v_mfma_f32_16x16x32_bf16 v[244:247], v[128:131], v[92:95], v[244:247]
v_mfma_f32_16x16x32_bf16 v[248:251], v[132:135], v[112:115], v[248:251]
v_mfma_f32_16x16x32_bf16 v[252:255], v[132:135], v[92:95], v[252:255]
s_waitcnt lgkmcnt(0)
v_mfma_f32_16x16x32_bf16 v[216:219], v[152:155], v[56:59], v[216:219]
v_mfma_f32_16x16x32_bf16 v[220:223], v[156:159], v[76:79], v[220:223]
v_mfma_f32_16x16x32_bf16 v[224:227], v[160:163], v[56:59], v[224:227]
v_mfma_f32_16x16x32_bf16 v[228:231], v[164:167], v[76:79], v[228:231]
v_mfma_f32_16x16x32_bf16 v[232:235], v[164:167], v[56:59], v[232:235]
v_mfma_f32_16x16x32_bf16 v[236:239], v[152:155], v[96:99], v[236:239]
v_mfma_f32_16x16x32_bf16 v[240:243], v[156:159], v[116:119], v[240:243]
v_mfma_f32_16x16x32_bf16 v[244:247], v[160:163], v[96:99], v[244:247]
v_mfma_f32_16x16x32_bf16 v[248:251], v[164:167], v[116:119], v[248:251]
v_mfma_f32_16x16x32_bf16 v[252:255], v[164:167], v[96:99], v[252:255]
s_add_u32 s27, s48, 0
s_lshl_b32 s27, s27, 4
v_add_u32 v7, s27, v13
v_mul_u32_u24 v6, 3277, v7
v_lshrrev_b32 v6, 16, v6
v_mul_u32_u24 v2, 20, v6
v_sub_u32 v7, v7, v2
s_cmp_eq_u32 s49, 0
s_cselect_b32 s27, 80, 0
s_add_u32 s27, s27, 122880
v_mul_u32_u24 v2, 192, v6
v_lshl_add_u32 v2, v7, 2, v2
v_add_u32 v2, s27, v2
v_cmp_gt_u32 vcc, 4, v6
v_mov_b32 v15, 123056
s_nop 0
v_cndmask_b32 v2, v15, v2, vcc
v_cndmask_b32 v228, v228, v232, s[56:57]
v_sub_f32 v120, v216, v220
v_sub_f32 v121, v217, v221
v_sub_f32 v122, v218, v222
v_sub_f32 v123, v219, v223
v_add_f32 v128, v216, v220
v_add_f32 v129, v217, v221
v_add_f32 v130, v218, v222
v_add_f32 v131, v219, v223
v_add_f32 v124, v228, v224
v_add_f32 v125, v229, v225
v_add_f32 v126, v230, v226
v_add_f32 v127, v231, v227
v_sub_f32 v132, v228, v224
v_sub_f32 v133, v229, v225
v_sub_f32 v134, v230, v226
v_sub_f32 v135, v231, v227
v_cndmask_b32 v120, v120, v216, s[54:55]
v_cndmask_b32 v124, v124, v228, s[54:55]
v_cndmask_b32 v128, v128, v224, s[54:55]
v_cndmask_b32 v132, v132, v220, s[54:55]
v_cvt_pk_bf16_f32 v136, v120, v124
v_cvt_pk_bf16_f32 v140, v128, v132
v_cvt_pk_bf16_f32 v137, v121, v125
v_cvt_pk_bf16_f32 v141, v129, v133
v_cvt_pk_bf16_f32 v138, v122, v126
v_cvt_pk_bf16_f32 v142, v130, v134
v_cvt_pk_bf16_f32 v139, v123, v127
v_cvt_pk_bf16_f32 v143, v131, v135
v_add_u32 v3, v2, v8
v_add_u32 v4, v2, v9
v_add_u32 v5, v2, v10
ds_write_b32 v3, v136 offset:0
ds_write_b32 v5, v140 offset:2304
ds_write_b32 v3, v137 offset:768
ds_write_b32 v4, v141 offset:1536
ds_write_b32 v3, v138 offset:1536
ds_write_b32 v4, v142 offset:768
ds_write_b32 v3, v139 offset:2304
ds_write_b32 v4, v143 offset:0
s_cmp_lg_u32 s49, 0
s_cbranch_scc1 L_b_nda0
v_mul_u32_u24 v2, 192, v6
v_add_u32 v2, 122848, v2
v_cmp_eq_u32 vcc, 0, v7
v_cmp_lt_u32 s[28:29], 0, v6
s_and_b64 vcc, vcc, s[28:29]
v_cndmask_b32 v2, v15, v2, vcc
v_add_u32 v3, v2, v8
v_add_u32 v4, v2, v9
v_add_u32 v5, v2, v10
ds_write_b32 v3, v136 offset:0
ds_write_b32 v5, v140 offset:2304
ds_write_b32 v3, v137 offset:768
ds_write_b32 v4, v141 offset:1536
ds_write_b32 v3, v138 offset:1536
ds_write_b32 v4, v142 offset:768
ds_write_b32 v3, v139 offset:2304
ds_write_b32 v4, v143 offset:0
L_b_nda0:
s_add_u32 s27, s48, 1
s_lshl_b32 s27, s27, 4
v_add_u32 v7, s27, v13
v_mul_u32_u24 v6, 3277, v7
v_lshrrev_b32 v6, 16, v6
v_mul_u32_u24 v2, 20, v6
v_sub_u32 v7, v7, v2
s_cmp_eq_u32 s49, 0
s_cselect_b32 s27, 80, 0
s_add_u32 s27, s27, 122880
v_mul_u32_u24 v2, 192, v6
v_lshl_add_u32 v2, v7, 2, v2
v_add_u32 v2, s27, v2
v_cmp_gt_u32 vcc, 4, v6
v_mov_b32 v15, 123056
s_nop 0
v_cndmask_b32 v2, v15, v2, vcc
v_cndmask_b32 v248, v248, v252, s[56:57]
v_sub_f32 v120, v236, v240
v_sub_f32 v121, v237, v241
v_sub_f32 v122, v238, v242
v_sub_f32 v123, v239, v243
v_add_f32 v128, v236, v240
v_add_f32 v129, v237, v241
v_add_f32 v130, v238, v242
v_add_f32 v131, v239, v243
v_add_f32 v124, v248, v244
v_add_f32 v125, v249, v245
v_add_f32 v126, v250, v246
v_add_f32 v127, v251, v247
v_sub_f32 v132, v248, v244
v_sub_f32 v133, v249, v245
v_sub_f32 v134, v250, v246
v_sub_f32 v135, v251, v247
v_cndmask_b32 v120, v120, v236, s[54:55]
v_cndmask_b32 v124, v124, v248, s[54:55]
v_cndmask_b32 v128, v128, v244, s[54:55]
v_cndmask_b32 v132, v132, v240, s[54:55]
v_cvt_pk_bf16_f32 v136, v120, v124
v_cvt_pk_bf16_f32 v140, v128, v132
v_cvt_pk_bf16_f32 v137, v121, v125
v_cvt_pk_bf16_f32 v141, v129, v133
v_cvt_pk_bf16_f32 v138, v122, v126
v_cvt_pk_bf16_f32 v142, v130, v134
v_cvt_pk_bf16_f32 v139, v123, v127
v_cvt_pk_bf16_f32 v143, v131, v135
v_add_u32 v3, v2, v8
v_add_u32 v4, v2, v9
v_add_u32 v5, v2, v10
ds_write_b32 v3, v136 offset:0
ds_write_b32 v5, v140 offset:2304
ds_write_b32 v3, v137 offset:768
ds_write_b32 v4, v141 offset:1536
ds_write_b32 v3, v138 offset:1536
ds_write_b32 v4, v142 offset:768
ds_write_b32 v3, v139 offset:2304
ds_write_b32 v4, v143 offset:0
s_cmp_lg_u32 s49, 0
s_cbranch_scc1 L_b_ndb0
v_mul_u32_u24 v2, 192, v6
v_add_u32 v2, 122848, v2
v_cmp_eq_u32 vcc, 0, v7
v_cmp_lt_u32 s[28:29], 0, v6
s_and_b64 vcc, vcc, s[28:29]
v_cndmask_b32 v2, v15, v2, vcc
v_add_u32 v3, v2, v8
v_add_u32 v4, v2, v9
v_add_u32 v5, v2, v10
ds_write_b32 v3, v136 offset:0
ds_write_b32 v5, v140 offset:2304
ds_write_b32 v3, v137 offset:768
ds_write_b32 v4, v141 offset:1536
ds_write_b32 v3, v138 offset:1536
ds_write_b32 v4, v142 offset:768
ds_write_b32 v3, v139 offset:2304
ds_write_b32 v4, v143 offset:0
L_b_ndb0:
s_branch L_b_end
L_b_h10:
s_waitcnt lgkmcnt(4)
v_mfma_f32_16x16x32_bf16 v[216:219], v[120:123], v[40:43], 0
ds_read_b128 v[184:187], v11 offset:2048
v_mfma_f32_16x16x32_bf16 v[220:223], v[124:127], v[60:63], 0
ds_read_b128 v[188:191], v11 offset:7168
v_mfma_f32_16x16x32_bf16 v[224:227], v[128:131], v[40:43], 0
ds_read_b128 v[192:195], v11 offset:12288
v_mfma_f32_16x16x32_bf16 v[228:231], v[132:135], v[60:63], 0
ds_read_b128 v[196:199], v11 offset:17408
v_mfma_f32_16x16x32_bf16 v[232:235], v[132:135], v[40:43], 0
s_waitcnt lgkmcnt(4)
v_mfma_f32_16x16x32_bf16 v[216:219], v[152:155], v[44:47], v[216:219]
ds_read_b128 v[120:123], v11 offset:3072
v_mfma_f32_16x16x32_bf16 v[220:223], v[156:159], v[64:67], v[220:223]
ds_read_b128 v[124:127], v11 offset:8192
v_mfma_f32_16x16x32_bf16 v[224:227], v[160:163], v[44:47], v[224:227]
ds_read_b128 v[128:131], v11 offset:13312
v_mfma_f32_16x16x32_bf16 v[228:231], v[164:167], v[64:67], v[228:231]
ds_read_b128 v[132:135], v11 offset:18432
v_mfma_f32_16x16x32_bf16 v[232:235], v[164:167], v[44:47], v[232:235]
s_waitcnt lgkmcnt(4)
v_mfma_f32_16x16x32_bf16 v[216:219], v[184:187], v[48:51], v[216:219]
ds_read_b128 v[152:155], v11 offset:4096
v_mfma_f32_16x16x32_bf16 v[220:223], v[188:191], v[68:71], v[220:223]
ds_read_b128 v[156:159], v11 offset:9216
v_mfma_f32_16x16x32_bf16 v[224:227], v[192:195], v[48:51], v[224:227]
ds_read_b128 v[160:163], v11 offset:14336
v_mfma_f32_16x16x32_bf16 v[228:231], v[196:199], v[68:71], v[228:231]
ds_read_b128 v[164:167], v11 offset:19456
v_mfma_f32_16x16x32_bf16 v[232:235], v[196:199], v[48:51], v[232:235]
s_waitcnt lgkmcnt(4)
v_mfma_f32_16x16x32_bf16 v[216:219], v[120:123], v[52:55], v[216:219]
v_mfma_f32_16x16x32_bf16 v[220:223], v[124:127], v[72:75], v[220:223]
v_mfma_f32_16x16x32_bf16 v[224:227], v[128:131], v[52:55], v[224:227]
v_mfma_f32_16x16x32_bf16 v[228:231], v[132:135], v[72:75], v[228:231]
v_mfma_f32_16x16x32_bf16 v[232:235], v[132:135], v[52:55], v[232:235]
s_waitcnt lgkmcnt(0)
v_mfma_f32_16x16x32_bf16 v[216:219], v[152:155], v[56:59], v[216:219]
v_mfma_f32_16x16x32_bf16 v[220:223], v[156:159], v[76:79], v[220:223]
v_mfma_f32_16x16x32_bf16 v[224:227], v[160:163], v[56:59], v[224:227]
v_mfma_f32_16x16x32_bf16 v[228:231], v[164:167], v[76:79], v[228:231]
v_mfma_f32_16x16x32_bf16 v[232:235], v[164:167], v[56:59], v[232:235]
s_add_u32 s27, s48, 0
s_lshl_b32 s27, s27, 4
v_add_u32 v7, s27, v13
v_mul_u32_u24 v6, 3277, v7
v_lshrrev_b32 v6, 16, v6
v_mul_u32_u24 v2, 20, v6
v_sub_u32 v7, v7, v2
s_cmp_eq_u32 s49, 0
s_cselect_b32 s27, 80, 0
s_add_u32 s27, s27, 122880
v_mul_u32_u24 v2, 192, v6
v_lshl_add_u32 v2, v7, 2, v2
v_add_u32 v2, s27, v2
v_cmp_gt_u32 vcc, 4, v6
v_mov_b32 v15, 123056
s_nop 0
v_cndmask_b32 v2, v15, v2, vcc
v_cndmask_b32 v228, v228, v232, s[56:57]
v_sub_f32 v120, v216, v220
v_sub_f32 v121, v217, v221
v_sub_f32 v122, v218, v222
v_sub_f32 v123, v219, v223
v_add_f32 v128, v216, v220
v_add_f32 v129, v217, v221
v_add_f32 v130, v218, v222
v_add_f32 v131, v219, v223
v_add_f32 v124, v228, v224
v_add_f32 v125, v229, v225
v_add_f32 v126, v230, v226
v_add_f32 v127, v231, v227
v_sub_f32 v132, v228, v224
v_sub_f32 v133, v229, v225
v_sub_f32 v134, v230, v226
v_sub_f32 v135, v231, v227
v_cndmask_b32 v120, v120, v216, s[54:55]
v_cndmask_b32 v124, v124, v228, s[54:55]
v_cndmask_b32 v128, v128, v224, s[54:55]
v_cndmask_b32 v132, v132, v220, s[54:55]
v_cvt_pk_bf16_f32 v136, v120, v124
v_cvt_pk_bf16_f32 v140, v128, v132
v_cvt_pk_bf16_f32 v137, v121, v125
v_cvt_pk_bf16_f32 v141, v129, v133
v_cvt_pk_bf16_f32 v138, v122, v126
v_cvt_pk_bf16_f32 v142, v130, v134
v_cvt_pk_bf16_f32 v139, v123, v127
v_cvt_pk_bf16_f32 v143, v131, v135
v_add_u32 v3, v2, v8
v_add_u32 v4, v2, v9
v_add_u32 v5, v2, v10
ds_write_b32 v3, v136 offset:0
ds_write_b32 v5, v140 offset:2304
ds_write_b32 v3, v137 offset:768
ds_write_b32 v4, v141 offset:1536
ds_write_b32 v3, v138 offset:1536
ds_write_b32 v4, v142 offset:768
ds_write_b32 v3, v139 offset:2304
ds_write_b32 v4, v143 offset:0
s_cmp_lg_u32 s49, 0
s_cbranch_scc1 L_b_ndc0
v_mul_u32_u24 v2, 192, v6
v_add_u32 v2, 122848, v2
v_cmp_eq_u32 vcc, 0, v7
v_cmp_lt_u32 s[28:29], 0, v6
s_and_b64 vcc, vcc, s[28:29]
v_cndmask_b32 v2, v15, v2, vcc
v_add_u32 v3, v2, v8
v_add_u32 v4, v2, v9
v_add_u32 v5, v2, v10
ds_write_b32 v3, v136 offset:0
ds_write_b32 v5, v140 offset:2304
ds_write_b32 v3, v137 offset:768
ds_write_b32 v4, v141 offset:1536
ds_write_b32 v3, v138 offset:1536
ds_write_b32 v4, v142 offset:768
ds_write_b32 v3, v139 offset:2304
ds_write_b32 v4, v143 offset:0
L_b_ndc0:
L_b_end:
s_load_dwordx2 s[96:97], s[16:17], 0
s_lshl_b32 s27, s20, 10
v_lshl_add_u32 v2, v0, 4, s27
v_add_u32 v3, 122880, v2
s_mul_i32 s28, s23, 57344
s_add_u32 s28, s28, 3178496
s_lshl_b32 s27, s26, 15
s_sub_u32 s28, s28, s27
s_waitcnt lgkmcnt(0)
s_cmp_lg_u32 s96, 0
s_cbranch_scc1 L_tg16
s_movk_i32 s59, 30000
v_mov_b32 v6, 0
L_th16:
s_sleep 8
buffer_load_dwordx2 v[4:5], v6, s[16:19], 0 offen sc1
s_waitcnt vmcnt(0)
v_readfirstlane_b32 s96, v4
v_readfirstlane_b32 s97, v5
s_sub_u32 s59, s59, 1
s_cbranch_scc1 L_tg16
s_cmp_eq_u32 s96, 0
s_cbranch_scc1 L_th16
s_nop 1
L_tg16:
s_barrier
s_lshl_b32 s29, s23, 1
s_add_u32 s29, s29, s26
s_lshl_b32 s29, s29, 7
ds_read_b128 v[16:19], v3 offset:0
ds_read_b128 v[20:23], v3 offset:8192
ds_read_b128 v[24:27], v3 offset:16384
ds_read_b128 v[28:31], v3 offset:24576
s_waitcnt lgkmcnt(3)
buffer_store_dwordx4 v[16:19], v2, s[12:15], s28 offen sc1
s_add_u32 s28, s28, 8192
s_waitcnt lgkmcnt(2)
buffer_store_dwordx4 v[20:23], v2, s[12:15], s28 offen sc1
s_add_u32 s28, s28, 8192
s_and_b32 s27, s26, s25
s_cbranch_scc1 L_b_n6
s_waitcnt lgkmcnt(1)
buffer_store_dwordx4 v[24:27], v2, s[12:15], s28 offen sc1
s_add_u32 s28, s28, 8192
L_b_n6:
s_lshl_b32 s56, s21, 14
s_add_u32 s56, s56, 5255168
s_lshl_b32 s57, s84, 7
s_add_u32 s57, s57, s56
s_load_dwordx2 s[50:51], s[12:13], s57
s_add_u32 s57, s57, 1024
s_load_dwordx2 s[52:53], s[12:13], s57
s_add_u32 s57, s57, 1024
s_load_dwordx2 s[44:45], s[12:13], s57
s_add_u32 s57, s57, 1024
s_load_dwordx2 s[46:47], s[12:13], s57
s_add_u32 s27, s29, 5373952
v_lshrrev_b32 v8, 3, v0
v_lshlrev_b32 v8, 13, v8
v_and_b32 v3, 7, v0
v_lshl_add_u32 v8, v3, 4, v8
v_mov_b32 v4, s96
v_mov_b32 v5, s97
v_mov_b32 v6, s96
v_mov_b32 v7, s97
s_cmp_lg_u32 s20, 0
s_waitcnt vmcnt(0) lgkmcnt(0)
s_barrier
s_cbranch_scc1 L_2_ent
buffer_store_dwordx4 v[4:7], v8, s[12:15], s27 offen sc1
s_nop 0
s_branch L_2_ent
L_2_ent:
s_cmp_lt_u32 s20, 4
s_cbranch_scc1 L_2_comp
s_waitcnt lgkmcnt(0)
s_xor_b64 s[50:51], s[50:51], s[96:97]
s_xor_b64 s[52:53], s[52:53], s[96:97]
s_xor_b64 s[44:45], s[44:45], s[96:97]
s_xor_b64 s[46:47], s[46:47], s[96:97]
s_or_b64 s[50:51], s[50:51], s[52:53]
s_or_b64 s[44:45], s[44:45], s[46:47]
s_or_b64 s[50:51], s[50:51], s[44:45]
s_cbranch_scc0 L_fh7
s_lshl_b32 s57, 0x01010101, s84
v_lshlrev_b32 v4, 7, v0
s_mov_b32 exec_lo, s57
s_mov_b32 exec_hi, 0
s_movk_i32 s59, 30000
L_pl8:
buffer_load_dwordx2 v[2:3], v4, s[12:15], s56 offen sc1
L_pm8:
s_sub_u32 s59, s59, 1
s_cbranch_scc1 L_pd8
s_waitcnt vmcnt(0)
v_cmp_ne_u64 vcc, s[96:97], v[2:3]
s_cbranch_vccz L_pd8
s_mov_b64 exec, vcc
s_sleep 4
s_branch L_pl8
L_pd8:
s_mov_b64 exec, -1
L_fh7:
v_lshlrev_b32 v26, 4, v0
s_sub_u32 s27, s20, 4
s_mul_i32 s39, s27, 5120
s_mul_i32 s38, s84, 102400
s_add_u32 s38, s38, s39
s_add_u32 s38, s38, 7340032
s_mov_b32 m0, s39
s_add_u32 s39, s39, 20480
buffer_load_dwordx4 v26, s[12:15], s38 offen offset:0 sc1 lds
buffer_load_dwordx4 v26, s[12:15], s38 offen offset:1024 sc1 lds
buffer_load_dwordx4 v26, s[12:15], s38 offen offset:2048 sc1 lds
buffer_load_dwordx4 v26, s[12:15], s38 offen offset:3072 sc1 lds
s_add_u32 m0, m0, 4096
s_add_u32 s38, s38, 4096
buffer_load_dwordx4 v26, s[12:15], s38 offen sc1 lds
s_add_u32 s38, s38, 16384
s_mov_b32 m0, s39
s_add_u32 s39, s39, 20480
buffer_load_dwordx4 v26, s[12:15], s38 offen offset:0 sc1 lds
buffer_load_dwordx4 v26, s[12:15], s38 offen offset:1024 sc1 lds
buffer_load_dwordx4 v26, s[12:15], s38 offen offset:2048 sc1 lds
buffer_load_dwordx4 v26, s[12:15], s38 offen offset:3072 sc1 lds
s_add_u32 m0, m0, 4096
s_add_u32 s38, s38, 4096
buffer_load_dwordx4 v26, s[12:15], s38 offen sc1 lds
s_add_u32 s38, s38, 16384
v_lshlrev_b32 v76, 7, v0
s_lshl_b32 s49, s21, 13
s_add_u32 s49, s49, 5373952
s_lshl_b32 s56, s21, 14
s_add_u32 s56, s56, 5255168
s_mov_b32 s48, 0
v_add_u32 v4, 0, v0
v_mul_u32_u24 v5, 13108, v4
v_lshrrev_b32 v5, 16, v5
v_mul_u32_u24 v5, 57264, v5
v_lshl_add_u32 v77, v4, 4, v5
v_add_u32 v4, 64, v0
v_mul_u32_u24 v5, 13108, v4
v_lshrrev_b32 v5, 16, v5
v_mul_u32_u24 v5, 57264, v5
v_lshl_add_u32 v78, v4, 4, v5
v_add_u32 v4, 128, v0
v_mul_u32_u24 v5, 13108, v4
v_lshrrev_b32 v5, 16, v5
v_mul_u32_u24 v5, 57264, v5
v_lshl_add_u32 v79, v4, 4, v5
s_sub_u32 s28, 7, s84
s_sub_u32 s29, 32, s85
s_and_b32 s29, s29, 31
s_lshl_b32 s43, s29, 3
s_add_u32 s43, s43, s28
s_mul_i32 s43, s43, 80
s_add_u32 s43, s43, 3145728
s_lshl_b32 s41, s85, 3
s_add_u32 s41, s41, s84
s_mul_i32 s41, s41, 80
s_add_u32 s41, s41, 3145728
s_cmp_ge_u32 s84, 4
s_cselect_b32 s28, s28, s84
s_cselect_b32 s29, s29, s85
s_cselect_b32 s40, 4, 0
s_lshl_b32 s29, s29, 2
s_add_u32 s28, s28, s29
s_mul_i32 s28, s28, 192
s_add_u32 s42, s28, 3178496
s_add_u32 s40, s40, s42
s_add_u32 s40, s40, 80
s_lshl_b32 s28, s20, 2
s_add_u32 s28, s28, 112800
v_mov_b32 v80, s28
s_mov_b32 m0, s39
s_add_u32 s39, s39, 20480
buffer_load_dwordx4 v26, s[12:15], s38 offen offset:0 sc1 lds
buffer_load_dwordx4 v26, s[12:15], s38 offen offset:1024 sc1 lds
buffer_load_dwordx4 v26, s[12:15], s38 offen offset:2048 sc1 lds
buffer_load_dwordx4 v26, s[12:15], s38 offen offset:3072 sc1 lds
s_add_u32 m0, m0, 4096
s_add_u32 s38, s38, 4096
buffer_load_dwordx4 v26, s[12:15], s38 offen sc1 lds
s_add_u32 s38, s38, 16384
s_mov_b32 m0, s39
s_add_u32 s39, s39, 20480
buffer_load_dwordx4 v26, s[12:15], s38 offen offset:0 sc1 lds
buffer_load_dwordx4 v26, s[12:15], s38 offen offset:1024 sc1 lds
buffer_load_dwordx4 v26, s[12:15], s38 offen offset:2048 sc1 lds
buffer_load_dwordx4 v26, s[12:15], s38 offen offset:3072 sc1 lds
s_add_u32 m0, m0, 4096
s_add_u32 s38, s38, 4096
buffer_load_dwordx4 v26, s[12:15], s38 offen sc1 lds
s_add_u32 s38, s38, 16384
s_mov_b32 m0, s39
s_add_u32 s39, s39, 20480
buffer_load_dwordx4 v26, s[12:15], s38 offen offset:0 sc1 lds
buffer_load_dwordx4 v26, s[12:15], s38 offen offset:1024 sc1 lds
buffer_load_dwordx4 v26, s[12:15], s38 offen offset:2048 sc1 lds
buffer_load_dwordx4 v26, s[12:15], s38 offen offset:3072 sc1 lds
s_add_u32 m0, m0, 4096
s_add_u32 s38, s38, 4096
buffer_load_dwordx4 v26, s[12:15], s38 offen sc1 lds
s_add_u32 s38, s38, 16384
v_mov_b32 v16, 0
v_mov_b32 v17, 0
s_xor_b32 s27, s20, 4
s_or_b32 s27, s27, s48
s_cbranch_scc1 L_2_pk3
buffer_load_dwordx2 v[16:17], v76, s[12:15], s49 offen sc1
L_2_pk3:
v_mov_b32 v2, 112800
v_mov_b32 v3, 0
v_mov_b32 v4, s48
ds_write_b32 v80, v2 offset:16
s_cmp_lg_u32 s20, 4
s_cbranch_scc1 L_2_nz
ds_write_b32 v2, v4
ds_write_b32 v2, v3 offset:8
L_2_nz:
s_waitcnt vmcnt(0) lgkmcnt(0)
s_barrier
v_cmp_ne_u64 vcc, s[96:97], v[16:17]
s_cbranch_vccnz L_2_nt3
s_mov_b32 s48, 2
s_mov_b32 m0, 102400
s_mov_b32 exec_hi, -1
buffer_load_dwordx4 v77, s[12:15], s40 offen sc1 lds
s_mov_b32 m0, 103424
s_nop 0
buffer_load_dwordx4 v78, s[12:15], s40 offen sc1 lds
s_mov_b32 m0, 104448
s_mov_b32 exec_hi, 0
buffer_load_dwordx4 v79, s[12:15], s40 offen sc1 lds
s_mov_b32 m0, 104976
s_mov_b32 exec_hi, -1
buffer_load_dwordx4 v77, s[12:15], s41 offen sc1 lds
s_mov_b32 m0, 106000
s_nop 0
buffer_load_dwordx4 v78, s[12:15], s41 offen sc1 lds
s_mov_b32 m0, 107024
s_mov_b32 exec_hi, 0
buffer_load_dwordx4 v79, s[12:15], s41 offen sc1 lds
s_mov_b32 m0, 107552
s_mov_b32 exec_hi, -1
buffer_load_dwordx4 v77, s[12:15], s42 offen sc1 lds
s_mov_b32 m0, 108576
s_nop 0
buffer_load_dwordx4 v78, s[12:15], s42 offen sc1 lds
s_mov_b32 m0, 109600
s_mov_b32 exec_hi, 0
buffer_load_dwordx4 v79, s[12:15], s42 offen sc1 lds
s_mov_b32 m0, 110128
s_mov_b32 exec_hi, -1
buffer_load_dwordx4 v77, s[12:15], s43 offen sc1 lds
s_mov_b32 m0, 111152
s_nop 0
buffer_load_dwordx4 v78, s[12:15], s43 offen sc1 lds
s_mov_b32 m0, 112176
s_mov_b32 exec_hi, 0
buffer_load_dwordx4 v79, s[12:15], s43 offen sc1 lds
s_mov_b32 exec_hi, -1
L_2_nt3:
L_2_lb:
s_cmp_lg_u32 s20, 4
s_cbranch_scc1 L_2_le
s_cmp_eq_u32 s48, 1
s_cbranch_scc1 L_2_le
s_cmp_eq_u32 s48, 2
s_cbranch_scc1 L_2_nv
s_mov_b32 exec_lo, -1
s_mov_b32 exec_hi, -1
s_movk_i32 s59, 30000
L_pl9:
buffer_load_dwordx2 v[4:5], v76, s[12:15], s49 offen sc1
L_pm9:
s_sub_u32 s59, s59, 1
s_cbranch_scc1 L_pd9
s_waitcnt vmcnt(0)
v_cmp_ne_u64 vcc, s[96:97], v[4:5]
s_cbranch_vccz L_pd9
s_mov_b64 exec, vcc
s_sleep 8
s_branch L_pl9
L_pd9:
s_mov_b64 exec, -1
s_mov_b32 m0, 102400
s_mov_b32 exec_hi, -1
buffer_load_dwordx4 v77, s[12:15], s40 offen sc1 lds
s_mov_b32 m0, 103424
s_nop 0
buffer_load_dwordx4 v78, s[12:15], s40 offen sc1 lds
s_mov_b32 m0, 104448
s_mov_b32 exec_hi, 0
buffer_load_dwordx4 v79, s[12:15], s40 offen sc1 lds
s_mov_b32 m0, 104976
s_mov_b32 exec_hi, -1
buffer_load_dwordx4 v77, s[12:15], s41 offen sc1 lds
s_mov_b32 m0, 106000
s_nop 0
buffer_load_dwordx4 v78, s[12:15], s41 offen sc1 lds
s_mov_b32 m0, 107024
s_mov_b32 exec_hi, 0
buffer_load_dwordx4 v79, s[12:15], s41 offen sc1 lds
s_mov_b32 m0, 107552
s_mov_b32 exec_hi, -1
buffer_load_dwordx4 v77, s[12:15], s42 offen sc1 lds
s_mov_b32 m0, 108576
s_nop 0
buffer_load_dwordx4 v78, s[12:15], s42 offen sc1 lds
s_mov_b32 m0, 109600
s_mov_b32 exec_hi, 0
buffer_load_dwordx4 v79, s[12:15], s42 offen sc1 lds
s_mov_b32 m0, 110128
s_mov_b32 exec_hi, -1
buffer_load_dwordx4 v77, s[12:15], s43 offen sc1 lds
s_mov_b32 m0, 111152
s_nop 0
buffer_load_dwordx4 v78, s[12:15], s43 offen sc1 lds
s_mov_b32 m0, 112176
s_mov_b32 exec_hi, 0
buffer_load_dwordx4 v79, s[12:15], s43 offen sc1 lds
s_mov_b32 exec_hi, -1
L_2_nv:
v_mov_b32 v2, 112800
s_waitcnt vmcnt(0)
ds_write_b32 v2, v2
L_2_le:
s_waitcnt lgkmcnt(0)
L_end:
s_endpgm
L_2_bp:
ds_read2_b32 v[120:121], v248 offset0:0 offset1:20
ds_read2_b32 v[122:123], v248 offset0:40 offset1:60
ds_read2_b32 v[124:125], v248 offset0:160 offset1:180
ds_read2_b32 v[126:127], v248 offset0:200 offset1:220
ds_read2_b32 v[128:129], v249 offset0:0 offset1:20
ds_read2_b32 v[130:131], v249 offset0:40 offset1:60
ds_read2_b32 v[132:133], v249 offset0:160 offset1:180
ds_read2_b32 v[134:135], v249 offset0:200 offset1:220
ds_read2_b32 v[136:137], v250 offset0:0 offset1:20
ds_read2_b32 v[138:139], v250 offset0:40 offset1:60
ds_read2_b32 v[140:141], v250 offset0:160 offset1:180
ds_read2_b32 v[142:143], v250 offset0:200 offset1:220
ds_read2_b32 v[144:145], v251 offset0:0 offset1:20
ds_read2_b32 v[146:147], v251 offset0:40 offset1:60
ds_read2_b32 v[148:149], v251 offset0:160 offset1:180
ds_read2_b32 v[150:151], v251 offset0:200 offset1:220
ds_read2_b32 v[152:153], v252 offset0:0 offset1:20
ds_read2_b32 v[154:155], v252 offset0:40 offset1:60
ds_read2_b32 v[156:157], v252 offset0:160 offset1:180
ds_read2_b32 v[158:159], v252 offset0:200 offset1:220
s_mov_b32 s53, 1
s_waitcnt lgkmcnt(12)
v_pk_mul_f32 v[120:121], v[120:121], v[254:255]
v_pk_mul_f32 v[122:123], v[122:123], v[254:255] op_sel:[0,1]
v_pk_mul_f32 v[124:125], v[124:125], v[254:255] op_sel:[0,1]
v_pk_mul_f32 v[126:127], v[126:127], v[254:255] op_sel:[0,1]
s_waitcnt lgkmcnt(12)
v_pk_mul_f32 v[128:129], v[128:129], v[254:255]
v_pk_mul_f32 v[130:131], v[130:131], v[254:255] op_sel:[0,1]
v_pk_mul_f32 v[132:133], v[132:133], v[254:255] op_sel:[0,1]
v_pk_mul_f32 v[134:135], v[134:135], v[254:255] op_sel:[0,1]
s_waitcnt lgkmcnt(8)
v_pk_mul_f32 v[136:137], v[136:137], v[254:255]
v_pk_mul_f32 v[138:139], v[138:139], v[254:255] op_sel:[0,1]
v_pk_mul_f32 v[140:141], v[140:141], v[254:255] op_sel:[0,1]
v_pk_mul_f32 v[142:143], v[142:143], v[254:255] op_sel:[0,1]
s_waitcnt lgkmcnt(4)
v_pk_mul_f32 v[144:145], v[144:145], v[254:255]
v_pk_mul_f32 v[146:147], v[146:147], v[254:255] op_sel:[0,1]
v_pk_mul_f32 v[148:149], v[148:149], v[254:255] op_sel:[0,1]
v_pk_mul_f32 v[150:151], v[150:151], v[254:255] op_sel:[0,1]
s_waitcnt lgkmcnt(0)
v_pk_mul_f32 v[152:153], v[152:153], v[254:255]
v_pk_mul_f32 v[154:155], v[154:155], v[254:255] op_sel:[0,1]
v_pk_mul_f32 v[156:157], v[156:157], v[254:255] op_sel:[0,1]
v_pk_mul_f32 v[158:159], v[158:159], v[254:255] op_sel:[0,1]
v_mfma_f32_16x16x32_bf16 v[180:183], v[120:123], v[240:243], 0
v_mfma_f32_16x16x32_bf16 v[184:187], v[128:131], v[240:243], 0
v_mfma_f32_16x16x32_bf16 v[188:191], v[136:139], v[240:243], 0
v_mfma_f32_16x16x32_bf16 v[192:195], v[144:147], v[240:243], 0
v_mfma_f32_16x16x32_bf16 v[196:199], v[152:155], v[240:243], 0
v_mfma_f32_16x16x32_bf16 v[180:183], v[124:127], v[244:247], v[180:183]
v_mfma_f32_16x16x32_bf16 v[184:187], v[132:135], v[244:247], v[184:187]
v_mfma_f32_16x16x32_bf16 v[188:191], v[140:143], v[244:247], v[188:191]
v_mfma_f32_16x16x32_bf16 v[192:195], v[148:151], v[244:247], v[192:195]
v_mfma_f32_16x16x32_bf16 v[196:199], v[156:159], v[244:247], v[196:199]
s_setpc_b64 s[56:57]
L_2_comp:
v_and_b32 v13, 15, v0
v_lshrrev_b32 v14, 4, v0
s_mov_b32 s53, 0
s_lshl_b32 s28, s20, 9
s_add_u32 s28, s28, s85
v_lshl_add_u32 v3, v13, 5, s28
v_cvt_f32_u32 v4, v3
v_mul_f32 v4, 0x3a000000, v4
v_and_b32 v5, 2, v14
v_add_u32 v14, v14, v5
v_lshlrev_b32 v5, 2, v14
v_cvt_f32_u32 v5, v5
v_mul_f32 v5, v4, v5
v_cos_f32 v7, v5
v_sin_f32 v6, v5
v_add_f32 v5, v5, v4
v_cvt_pk_bf16_f32 v240, -v7, v6
v_cos_f32 v7, v5
v_sin_f32 v6, v5
v_add_f32 v5, v5, v4
v_cvt_pk_bf16_f32 v241, -v7, v6
v_cos_f32 v7, v5
v_sin_f32 v6, v5
v_add_f32 v5, v5, v4
v_cvt_pk_bf16_f32 v242, -v7, v6
v_cos_f32 v7, v5
v_sin_f32 v6, v5
v_fmac_f32 v5, 0x40a00000, v4
v_cvt_pk_bf16_f32 v243, -v7, v6
v_cos_f32 v7, v5
v_sin_f32 v6, v5
v_add_f32 v5, v5, v4
v_cvt_pk_bf16_f32 v244, -v7, v6
v_cos_f32 v7, v5
v_sin_f32 v6, v5
v_add_f32 v5, v5, v4
v_cvt_pk_bf16_f32 v245, -v7, v6
v_cos_f32 v7, v5
v_sin_f32 v6, v5
v_add_f32 v5, v5, v4
v_cvt_pk_bf16_f32 v246, -v7, v6
v_cos_f32 v7, v5
v_sin_f32 v6, v5
s_nop 0
v_cvt_pk_bf16_f32 v247, -v7, v6
v_lshlrev_b32 v6, 31, v0
v_xor_b32 v6, 0xbf80bf80, v6
v_cmp_gt_u32 vcc, 16, v0
s_cmp_ge_u32 s84, 4
s_cselect_b32 s30, 0x55555555, 0
v_cndmask_b32 v240, v240, v6, vcc
s_or_b32 s30, s30, 0x88888888
s_mov_b32 s31, s30
s_mov_b32 s28, 102400
v_and_b32 v6, 3, v0
v_mul_u32_u24 v6, 2576, v6
v_mul_u32_u24 v7, 320, v14
v_add3_u32 v6, v6, v7, s28
v_and_b32 v7, 12, v0
v_sub_u32 v8, 76, v7
v_cndmask_b32 v7, v7, v8, s[30:31]
v_add_u32 v248, v6, v7
v_cndmask_b32 v7, 16, -16, s[30:31]
v_add_u32 v249, v248, v7
v_add_u32 v250, v249, v7
v_add_u32 v251, v250, v7
v_add_u32 v252, v251, v7
v_lshrrev_b32 v14, 4, v0
v_cndmask_b32 v255, 1.0, -1.0, s[30:31]
s_cmp_eq_u32 s85, 0
s_cselect_b32 s28, 0xffff0000, -1
s_and_b32 s30, s30, s28
v_cndmask_b32 v254, 1.0, -1.0, s[30:31]
v_lshlrev_b32 v26, 4, v0
v_add_u32 v27, 51200, v26
s_mul_i32 s28, s20, 2816
s_add_u32 s28, s28, 112896
v_mul_u32_u24 v6, 176, v13
v_lshl_add_u32 v6, v14, 3, v6
v_add_u32 v29, s28, v6
v_add_u32 v6, 0, v0
v_mul_u32_u24 v7, 6554, v6
v_lshrrev_b32 v7, 16, v7
v_add_u32 v8, v6, v7
v_lshl_add_u32 v30, v8, 4, s28
v_mul_u32_u24 v7, 40800, v7
v_lshl_add_u32 v33, v6, 4, v7
v_add_u32 v6, 64, v0
v_mul_u32_u24 v7, 6554, v6
v_lshrrev_b32 v7, 16, v7
v_add_u32 v8, v6, v7
v_lshl_add_u32 v31, v8, 4, s28
v_mul_u32_u24 v7, 40800, v7
v_lshl_add_u32 v34, v6, 4, v7
v_add_u32 v6, 128, v0
v_mul_u32_u24 v7, 6554, v6
v_lshrrev_b32 v7, 16, v7
v_add_u32 v8, v6, v7
v_lshl_add_u32 v32, v8, 4, s28
v_mul_u32_u24 v7, 40800, v7
v_lshl_add_u32 v35, v6, 4, v7
s_lshl_b32 s45, s20, 9
s_add_u32 s45, s45, s85
s_mul_i32 s45, s45, 1280
s_mul_i32 s30, s84, 160
s_add_u32 s45, s45, s30
s_mul_i32 s44, s85, 81920
s_mul_i32 s30, s20, 20480
s_add_u32 s44, s44, s30
s_add_u32 s44, s44, 0
s_lshl_b32 s46, s85, 2
s_add_u32 s46, s46, s20
s_lshl_b32 s46, s46, 6
s_add_u32 s46, s46, 2621440
s_lshl_b32 s47, s21, 14
s_add_u32 s47, s47, 5242880
v_lshlrev_b32 v3, 2, v13
v_lshlrev_b32 v4, 7, v0
v_lshrrev_b32 v6, 5, v0
v_lshlrev_b32 v6, 9, v6
v_lshl_add_u32 v6, v13, 5, v6
v_and_b32 v7, 16, v0
v_add_u32 v2, v6, v7
v_mov_b32 v24, 112800
s_mov_b32 s51, s44
s_movk_i32 s52, 30000
s_barrier
L_2_go:
s_cmp_lg_u32 s20, 0
s_cbranch_scc1 L_gw10
s_mov_b32 s54, 0xfffff
s_mov_b32 s55, 0
s_movk_i32 s58, 30000
L_gp10:
s_mov_b64 exec, s[54:55]
buffer_load_dwordx2 v[22:23], v4, s[12:15], s47 offen sc1
s_mov_b64 exec, -1
s_cmp_eq_u32 s53, 1
s_cbranch_scc1 L_bt11
ds_read_b32 v25, v24
s_waitcnt lgkmcnt(0)
v_cmp_eq_u32 vcc, 0, v25
s_cbranch_vccnz L_bt11
s_call_b64 s[56:57], L_2_bp
L_bt11:
L_gr10:
s_sub_u32 s58, s58, 1
s_cbranch_scc1 L_gq10
s_waitcnt vmcnt(0)
v_cmp_ne_u64 vcc, s[96:97], v[22:23]
s_and_b64 s[54:55], s[54:55], vcc
s_cbranch_scc0 L_gq10
s_sleep 3
s_branch L_gp10
L_gq10:
ds_write_b32 v24, v24 offset:8
s_branch L_gd10
L_gw10:
s_mov_b32 s58, 262144
L_gx10:
ds_read_b32 v10, v24 offset:8
s_sub_u32 s58, s58, 1
s_cbranch_scc1 L_gd10
s_waitcnt lgkmcnt(0)
v_cmp_eq_u32 vcc, 0, v10
s_cbranch_vccz L_gd10
s_cmp_eq_u32 s53, 1
s_cbranch_scc1 L_bt12
ds_read_b32 v25, v24
s_waitcnt lgkmcnt(0)
v_cmp_eq_u32 vcc, 0, v25
s_cbranch_vccnz L_bt12
s_call_b64 s[56:57], L_2_bp
L_bt12:
s_sleep 1
s_branch L_gx10
L_gd10:
L_2_g2:
L_2_st:
buffer_load_dword v16, v3, s[12:15], s46 offen sc1
buffer_load_dwordx4 v[40:43], v2, s[12:15], s44 offen offset:0 sc1
buffer_load_dwordx4 v[44:47], v2, s[12:15], s44 offen offset:1024 sc1
buffer_load_dwordx4 v[48:51], v2, s[12:15], s44 offen offset:2048 sc1
buffer_load_dwordx4 v[52:55], v2, s[12:15], s44 offen offset:3072 sc1
s_add_u32 s44, s44, 4096
buffer_load_dwordx4 v[56:59], v2, s[12:15], s44 offen offset:0 sc1
buffer_load_dwordx4 v[60:63], v2, s[12:15], s44 offen offset:1024 sc1
buffer_load_dwordx4 v[64:67], v2, s[12:15], s44 offen offset:2048 sc1
buffer_load_dwordx4 v[68:71], v2, s[12:15], s44 offen offset:3072 sc1
s_add_u32 s44, s44, 4096
v_mov_b32 v10, 112832
s_cmp_lg_u32 s53, 1
s_cbranch_scc1 L_2_b0
L_2_b9:
ds_read_b128 v[120:123], v26 offset:0
ds_read_b128 v[124:127], v26 offset:1024
ds_read_b128 v[128:131], v26 offset:2048
ds_read_b128 v[132:135], v26 offset:3072
ds_read_b128 v[136:139], v26 offset:4096
ds_read_b128 v[140:143], v26 offset:5120
ds_read_b128 v[144:147], v26 offset:6144
ds_read_b128 v[148:151], v26 offset:7168
ds_read_b128 v[152:155], v26 offset:8192
ds_read_b128 v[156:159], v26 offset:9216
ds_read_b128 v[200:203], v26 offset:10240
ds_read_b128 v[204:207], v26 offset:11264
ds_read_b128 v[208:211], v26 offset:12288
ds_read_b128 v[212:215], v26 offset:13312
ds_read_b128 v[216:219], v26 offset:14336
s_waitcnt vmcnt(6)
v_max3_u32 v5, v16, v40, v44
v_cmp_eq_u32 vcc, 4290772927, v5
s_cbranch_vccnz L_2_h0
L_2_r0:
s_waitcnt lgkmcnt(0)
v_mfma_f32_16x16x32_bf16 v[160:163], v[120:123], v[40:43], v[180:183]
ds_read_b128 v[220:223], v26 offset:15360
buffer_load_dwordx4 v[72:75], v2, s[12:15], s44 offen offset:0 sc1
v_mfma_f32_16x16x32_bf16 v[164:167], v[124:127], v[40:43], v[184:187]
ds_read_b128 v[224:227], v26 offset:16384
buffer_load_dwordx4 v[76:79], v2, s[12:15], s44 offen offset:1024 sc1
v_mfma_f32_16x16x32_bf16 v[168:171], v[128:131], v[40:43], v[188:191]
ds_read_b128 v[228:231], v26 offset:17408
ds_read_b128 v[232:235], v26 offset:18432
v_mfma_f32_16x16x32_bf16 v[172:175], v[132:135], v[40:43], v[192:195]
ds_read_b128 v[236:239], v26 offset:19456
v_mfma_f32_16x16x32_bf16 v[176:179], v[136:139], v[40:43], v[196:199]
s_waitcnt lgkmcnt(10)
v_mfma_f32_16x16x32_bf16 v[160:163], v[140:143], v[44:47], v[160:163]
ds_read_b128 v[120:123], v26 offset:20480
v_mfma_f32_16x16x32_bf16 v[164:167], v[144:147], v[44:47], v[164:167]
ds_read_b128 v[124:127], v26 offset:21504
s_waitcnt vmcnt(6)
v_max3_u32 v5, v55, v48, v52
v_mfma_f32_16x16x32_bf16 v[168:171], v[148:151], v[44:47], v[168:171]
ds_read_b128 v[128:131], v26 offset:22528
v_cmp_eq_u32 vcc, 4290772927, v5
v_mfma_f32_16x16x32_bf16 v[172:175], v[152:155], v[44:47], v[172:175]
ds_read_b128 v[132:135], v26 offset:23552
ds_read_b128 v[136:139], v26 offset:24576
v_mfma_f32_16x16x32_bf16 v[176:179], v[156:159], v[44:47], v[176:179]
s_cbranch_vccnz L_2_h1
L_2_r1:
s_waitcnt lgkmcnt(10)
v_mfma_f32_16x16x32_bf16 v[160:163], v[200:203], v[48:51], v[160:163]
ds_read_b128 v[140:143], v26 offset:25600
buffer_load_dwordx4 v[80:83], v2, s[12:15], s44 offen offset:2048 sc1
v_mfma_f32_16x16x32_bf16 v[164:167], v[204:207], v[48:51], v[164:167]
ds_read_b128 v[144:147], v26 offset:26624
buffer_load_dwordx4 v[84:87], v2, s[12:15], s44 offen offset:3072 sc1
v_mfma_f32_16x16x32_bf16 v[168:171], v[208:211], v[48:51], v[168:171]
ds_read_b128 v[148:151], v26 offset:27648
s_add_u32 s44, s44, 4096
v_mfma_f32_16x16x32_bf16 v[172:175], v[212:215], v[48:51], v[172:175]
ds_read_b128 v[152:155], v26 offset:28672
ds_read_b128 v[156:159], v26 offset:29696
v_mfma_f32_16x16x32_bf16 v[176:179], v[216:219], v[48:51], v[176:179]
s_waitcnt lgkmcnt(10)
v_mfma_f32_16x16x32_bf16 v[160:163], v[220:223], v[52:55], v[160:163]
ds_read_b128 v[6:9], v10
v_mfma_f32_16x16x32_bf16 v[164:167], v[224:227], v[52:55], v[164:167]
ds_read_b128 v[200:203], v26 offset:30720
s_waitcnt vmcnt(6)
v_max3_u32 v5, v63, v56, v60
v_mfma_f32_16x16x32_bf16 v[168:171], v[228:231], v[52:55], v[168:171]
ds_read_b128 v[204:207], v26 offset:31744
v_cmp_eq_u32 vcc, 4290772927, v5
v_mfma_f32_16x16x32_bf16 v[172:175], v[232:235], v[52:55], v[172:175]
ds_read_b128 v[208:211], v26 offset:32768
ds_read_b128 v[212:215], v26 offset:33792
v_mfma_f32_16x16x32_bf16 v[176:179], v[236:239], v[52:55], v[176:179]
ds_read_b128 v[216:219], v26 offset:34816
s_cbranch_vccnz L_2_h2
L_2_r2:
s_waitcnt lgkmcnt(5)
v_mfma_f32_16x16x32_bf16 v[160:163], v[120:123], v[56:59], v[160:163]
ds_read_b128 v[220:223], v26 offset:35840
v_min3_u32 v6, v6, v7, v8
v_min_u32 v6, v6, v9
v_mfma_f32_16x16x32_bf16 v[164:167], v[124:127], v[56:59], v[164:167]
ds_read_b128 v[224:227], v26 offset:36864
v_cmp_eq_u32 vcc, 0, v6
v_mfma_f32_16x16x32_bf16 v[168:171], v[128:131], v[56:59], v[168:171]
ds_read_b128 v[228:231], v26 offset:37888
buffer_load_dwordx4 v[88:91], v2, s[12:15], s44 offen offset:0 sc1
v_mfma_f32_16x16x32_bf16 v[172:175], v[132:135], v[56:59], v[172:175]
ds_read_b128 v[232:235], v26 offset:38912
buffer_load_dwordx4 v[92:95], v2, s[12:15], s44 offen offset:1024 sc1
v_mfma_f32_16x16x32_bf16 v[176:179], v[136:139], v[56:59], v[176:179]
ds_read_b128 v[236:239], v26 offset:39936
s_cbranch_vccnz L_2_lw
L_2_lr:
s_waitcnt lgkmcnt(10)
v_mfma_f32_16x16x32_bf16 v[160:163], v[140:143], v[60:63], v[160:163]
ds_read_b128 v[120:123], v26 offset:40960
v_mfma_f32_16x16x32_bf16 v[164:167], v[144:147], v[60:63], v[164:167]
ds_read_b128 v[124:127], v26 offset:41984
s_waitcnt vmcnt(6)
v_max3_u32 v5, v71, v64, v68
v_mfma_f32_16x16x32_bf16 v[168:171], v[148:151], v[60:63], v[168:171]
ds_read_b128 v[128:131], v26 offset:43008
v_cmp_eq_u32 vcc, 4290772927, v5
v_mfma_f32_16x16x32_bf16 v[172:175], v[152:155], v[60:63], v[172:175]
ds_read_b128 v[132:135], v26 offset:44032
ds_read_b128 v[136:139], v26 offset:45056
v_mfma_f32_16x16x32_bf16 v[176:179], v[156:159], v[60:63], v[176:179]
s_cbranch_vccnz L_2_h3
L_2_r3:
s_waitcnt lgkmcnt(10)
v_mfma_f32_16x16x32_bf16 v[160:163], v[200:203], v[64:67], v[160:163]
ds_read_b128 v[140:143], v26 offset:46080
buffer_load_dwordx4 v[96:99], v2, s[12:15], s44 offen offset:2048 sc1
v_mfma_f32_16x16x32_bf16 v[164:167], v[204:207], v[64:67], v[164:167]
ds_read_b128 v[144:147], v26 offset:47104
buffer_load_dwordx4 v[100:103], v2, s[12:15], s44 offen offset:3072 sc1
v_mfma_f32_16x16x32_bf16 v[168:171], v[208:211], v[64:67], v[168:171]
ds_read_b128 v[148:151], v26 offset:48128
s_add_u32 s44, s44, 4096
v_mfma_f32_16x16x32_bf16 v[172:175], v[212:215], v[64:67], v[172:175]
ds_read_b128 v[152:155], v26 offset:49152
ds_read_b128 v[156:159], v26 offset:50176
v_mfma_f32_16x16x32_bf16 v[176:179], v[216:219], v[64:67], v[176:179]
s_waitcnt lgkmcnt(10)
v_mfma_f32_16x16x32_bf16 v[160:163], v[220:223], v[68:71], v[160:163]
ds_read_b128 v[200:203], v27 offset:0
v_mfma_f32_16x16x32_bf16 v[164:167], v[224:227], v[68:71], v[164:167]
ds_read_b128 v[204:207], v27 offset:1024
s_waitcnt vmcnt(6)
v_max3_u32 v5, v79, v72, v76
v_mfma_f32_16x16x32_bf16 v[168:171], v[228:231], v[68:71], v[168:171]
ds_read_b128 v[208:211], v27 offset:2048
v_cmp_eq_u32 vcc, 4290772927, v5
v_mfma_f32_16x16x32_bf16 v[172:175], v[232:235], v[68:71], v[172:175]
ds_read_b128 v[212:215], v27 offset:3072
ds_read_b128 v[216:219], v27 offset:4096
v_mfma_f32_16x16x32_bf16 v[176:179], v[236:239], v[68:71], v[176:179]
s_cbranch_vccnz L_2_h4
L_2_r4:
s_waitcnt lgkmcnt(10)
v_mfma_f32_16x16x32_bf16 v[160:163], v[120:123], v[72:75], v[160:163]
ds_read_b128 v[220:223], v27 offset:5120
buffer_load_dwordx4 v[104:107], v2, s[12:15], s44 offen offset:0 sc1
v_mfma_f32_16x16x32_bf16 v[164:167], v[124:127], v[72:75], v[164:167]
ds_read_b128 v[224:227], v27 offset:6144
buffer_load_dwordx4 v[108:111], v2, s[12:15], s44 offen offset:1024 sc1
v_mfma_f32_16x16x32_bf16 v[168:171], v[128:131], v[72:75], v[168:171]
ds_read_b128 v[228:231], v27 offset:7168
v_lshlrev_b32 v18, 16, v16
v_mfma_f32_16x16x32_bf16 v[172:175], v[132:135], v[72:75], v[172:175]
ds_read_b128 v[232:235], v27 offset:8192
ds_read_b128 v[236:239], v27 offset:9216
v_mfma_f32_16x16x32_bf16 v[176:179], v[136:139], v[72:75], v[176:179]
s_waitcnt lgkmcnt(10)
v_mfma_f32_16x16x32_bf16 v[160:163], v[140:143], v[76:79], v[160:163]
ds_read_b128 v[120:123], v27 offset:10240
v_mfma_f32_16x16x32_bf16 v[164:167], v[144:147], v[76:79], v[164:167]
ds_read_b128 v[124:127], v27 offset:11264
s_waitcnt vmcnt(6)
v_max3_u32 v5, v87, v80, v84
v_mfma_f32_16x16x32_bf16 v[168:171], v[148:151], v[76:79], v[168:171]
ds_read_b128 v[128:131], v27 offset:12288
v_cmp_eq_u32 vcc, 4290772927, v5
v_mfma_f32_16x16x32_bf16 v[172:175], v[152:155], v[76:79], v[172:175]
ds_read_b128 v[132:135], v27 offset:13312
ds_read_b128 v[136:139], v27 offset:14336
v_mfma_f32_16x16x32_bf16 v[176:179], v[156:159], v[76:79], v[176:179]
s_cbranch_vccnz L_2_h5
L_2_r5:
s_waitcnt lgkmcnt(10)
v_mfma_f32_16x16x32_bf16 v[160:163], v[200:203], v[80:83], v[160:163]
ds_read_b128 v[140:143], v27 offset:15360
buffer_load_dwordx4 v[112:115], v2, s[12:15], s44 offen offset:2048 sc1
v_mfma_f32_16x16x32_bf16 v[164:167], v[204:207], v[80:83], v[164:167]
ds_read_b128 v[144:147], v27 offset:16384
buffer_load_dwordx4 v[116:119], v2, s[12:15], s44 offen offset:3072 sc1
v_mfma_f32_16x16x32_bf16 v[168:171], v[208:211], v[80:83], v[168:171]
ds_read_b128 v[148:151], v27 offset:17408
v_mul_f32 v18, 0xbfb8aa3b, v18
v_mfma_f32_16x16x32_bf16 v[172:175], v[212:215], v[80:83], v[172:175]
ds_read_b128 v[152:155], v27 offset:18432
ds_read_b128 v[156:159], v27 offset:19456
v_mfma_f32_16x16x32_bf16 v[176:179], v[216:219], v[80:83], v[176:179]
s_waitcnt lgkmcnt(10)
v_mfma_f32_16x16x32_bf16 v[160:163], v[220:223], v[84:87], v[160:163]
ds_read_b128 v[200:203], v27 offset:20480
v_mfma_f32_16x16x32_bf16 v[164:167], v[224:227], v[84:87], v[164:167]
ds_read_b128 v[204:207], v27 offset:21504
s_waitcnt vmcnt(6)
v_max3_u32 v5, v95, v88, v92
v_mfma_f32_16x16x32_bf16 v[168:171], v[228:231], v[84:87], v[168:171]
ds_read_b128 v[208:211], v27 offset:22528
v_cmp_eq_u32 vcc, 4290772927, v5
v_mfma_f32_16x16x32_bf16 v[172:175], v[232:235], v[84:87], v[172:175]
ds_read_b128 v[212:215], v27 offset:23552
ds_read_b128 v[216:219], v27 offset:24576
v_mfma_f32_16x16x32_bf16 v[176:179], v[236:239], v[84:87], v[176:179]
s_cbranch_vccnz L_2_h6
L_2_r6:
s_waitcnt lgkmcnt(10)
v_mfma_f32_16x16x32_bf16 v[160:163], v[120:123], v[88:91], v[160:163]
ds_read_b128 v[220:223], v27 offset:25600
v_exp_f32 v18, v18
v_mfma_f32_16x16x32_bf16 v[164:167], v[124:127], v[88:91], v[164:167]
ds_read_b128 v[224:227], v27 offset:26624
ds_read_b128 v[228:231], v27 offset:27648
v_mfma_f32_16x16x32_bf16 v[168:171], v[128:131], v[88:91], v[168:171]
ds_read_b128 v[232:235], v27 offset:28672
ds_read_b128 v[236:239], v27 offset:29696
v_mfma_f32_16x16x32_bf16 v[172:175], v[132:135], v[88:91], v[172:175]
v_mfma_f32_16x16x32_bf16 v[176:179], v[136:139], v[88:91], v[176:179]
s_waitcnt lgkmcnt(10)
v_mfma_f32_16x16x32_bf16 v[160:163], v[140:143], v[92:95], v[160:163]
ds_read_b128 v[120:123], v27 offset:30720
v_mfma_f32_16x16x32_bf16 v[164:167], v[144:147], v[92:95], v[164:167]
ds_read_b128 v[124:127], v27 offset:31744
s_waitcnt vmcnt(4)
v_max3_u32 v5, v103, v96, v100
v_mfma_f32_16x16x32_bf16 v[168:171], v[148:151], v[92:95], v[168:171]
ds_read_b128 v[128:131], v27 offset:32768
v_cmp_eq_u32 vcc, 4290772927, v5
v_mfma_f32_16x16x32_bf16 v[172:175], v[152:155], v[92:95], v[172:175]
ds_read_b128 v[132:135], v27 offset:33792
ds_read_b128 v[136:139], v27 offset:34816
v_mfma_f32_16x16x32_bf16 v[176:179], v[156:159], v[92:95], v[176:179]
s_cbranch_vccnz L_2_h7
L_2_r7:
s_waitcnt lgkmcnt(10)
v_mfma_f32_16x16x32_bf16 v[160:163], v[200:203], v[96:99], v[160:163]
ds_read_b128 v[140:143], v27 offset:35840
v_add_f32 v18, 1.0, v18
v_mfma_f32_16x16x32_bf16 v[164:167], v[204:207], v[96:99], v[164:167]
ds_read_b128 v[144:147], v27 offset:36864
ds_read_b128 v[148:151], v27 offset:37888
v_mfma_f32_16x16x32_bf16 v[168:171], v[208:211], v[96:99], v[168:171]
ds_read_b128 v[152:155], v27 offset:38912
ds_read_b128 v[156:159], v27 offset:39936
v_mfma_f32_16x16x32_bf16 v[172:175], v[212:215], v[96:99], v[172:175]
v_mfma_f32_16x16x32_bf16 v[176:179], v[216:219], v[96:99], v[176:179]
s_waitcnt lgkmcnt(10)
v_mfma_f32_16x16x32_bf16 v[160:163], v[220:223], v[100:103], v[160:163]
ds_read_b128 v[200:203], v27 offset:40960
v_mfma_f32_16x16x32_bf16 v[164:167], v[224:227], v[100:103], v[164:167]
ds_read_b128 v[204:207], v27 offset:41984
s_waitcnt vmcnt(2)
v_max3_u32 v5, v111, v104, v108
v_mfma_f32_16x16x32_bf16 v[168:171], v[228:231], v[100:103], v[168:171]
ds_read_b128 v[208:211], v27 offset:43008
v_cmp_eq_u32 vcc, 4290772927, v5
v_mfma_f32_16x16x32_bf16 v[172:175], v[232:235], v[100:103], v[172:175]
ds_read_b128 v[212:215], v27 offset:44032
ds_read_b128 v[216:219], v27 offset:45056
v_mfma_f32_16x16x32_bf16 v[176:179], v[236:239], v[100:103], v[176:179]
s_cbranch_vccnz L_2_h8
L_2_r8:
s_waitcnt lgkmcnt(10)
v_mfma_f32_16x16x32_bf16 v[160:163], v[120:123], v[104:107], v[160:163]
ds_read_b128 v[220:223], v27 offset:46080
v_rcp_f32 v18, v18
v_mfma_f32_16x16x32_bf16 v[164:167], v[124:127], v[104:107], v[164:167]
ds_read_b128 v[224:227], v27 offset:47104
ds_read_b128 v[228:231], v27 offset:48128
v_mfma_f32_16x16x32_bf16 v[168:171], v[128:131], v[104:107], v[168:171]
ds_read_b128 v[232:235], v27 offset:49152
ds_read_b128 v[236:239], v27 offset:50176
v_mfma_f32_16x16x32_bf16 v[172:175], v[132:135], v[104:107], v[172:175]
v_mfma_f32_16x16x32_bf16 v[176:179], v[136:139], v[104:107], v[176:179]
s_waitcnt lgkmcnt(10)
v_mfma_f32_16x16x32_bf16 v[160:163], v[140:143], v[108:111], v[160:163]
s_waitcnt vmcnt(0)
v_max3_u32 v5, v119, v112, v116
v_mfma_f32_16x16x32_bf16 v[164:167], v[144:147], v[108:111], v[164:167]
v_cmp_eq_u32 vcc, 4290772927, v5
v_mfma_f32_16x16x32_bf16 v[168:171], v[148:151], v[108:111], v[168:171]
v_mfma_f32_16x16x32_bf16 v[172:175], v[152:155], v[108:111], v[172:175]
v_mfma_f32_16x16x32_bf16 v[176:179], v[156:159], v[108:111], v[176:179]
s_cbranch_vccnz L_2_h9
L_2_r9:
s_waitcnt lgkmcnt(0)
v_mfma_f32_16x16x32_bf16 v[160:163], v[200:203], v[112:115], v[160:163]
v_mfma_f32_16x16x32_bf16 v[160:163], v[220:223], v[116:119], v[160:163]
v_mfma_f32_16x16x32_bf16 v[164:167], v[204:207], v[112:115], v[164:167]
v_mfma_f32_16x16x32_bf16 v[164:167], v[224:227], v[116:119], v[164:167]
v_mfma_f32_16x16x32_bf16 v[168:171], v[208:211], v[112:115], v[168:171]
v_mfma_f32_16x16x32_bf16 v[168:171], v[228:231], v[116:119], v[168:171]
s_nop 3
v_fma_f32 v120, v160, v18, -v180
v_fma_f32 v121, v161, v18, -v181
v_fma_f32 v122, v162, v18, -v182
v_mfma_f32_16x16x32_bf16 v[172:175], v[212:215], v[112:115], v[172:175]
v_fma_f32 v123, v163, v18, -v183
v_cvt_pk_bf16_f32 v120, v120, v121
v_cvt_pk_bf16_f32 v121, v122, v123
v_mfma_f32_16x16x32_bf16 v[172:175], v[232:235], v[116:119], v[172:175]
ds_write_b64 v29, v[120:121] offset:0
v_fma_f32 v124, v164, v18, -v184
v_fma_f32 v125, v165, v18, -v185
v_mfma_f32_16x16x32_bf16 v[176:179], v[216:219], v[112:115], v[176:179]
v_fma_f32 v126, v166, v18, -v186
v_fma_f32 v127, v167, v18, -v187
v_cvt_pk_bf16_f32 v124, v124, v125
v_mfma_f32_16x16x32_bf16 v[176:179], v[236:239], v[116:119], v[176:179]
v_cvt_pk_bf16_f32 v125, v126, v127
ds_write_b64 v29, v[124:125] offset:32
v_cmp_u_f32 vcc, v160, v160
v_pk_fma_f32 v[128:129], v[168:169], v[18:19], v[188:189] op_sel_hi:[1,0,1] neg_lo:[0,0,1] neg_hi:[0,0,1]
v_pk_fma_f32 v[130:131], v[170:171], v[18:19], v[190:191] op_sel_hi:[1,0,1] neg_lo:[0,0,1] neg_hi:[0,0,1]
v_cvt_pk_bf16_f32 v128, v128, v129
v_cvt_pk_bf16_f32 v129, v130, v131
ds_write_b64 v29, v[128:129] offset:64
v_pk_fma_f32 v[132:133], v[172:173], v[18:19], v[192:193] op_sel_hi:[1,0,1] neg_lo:[0,0,1] neg_hi:[0,0,1]
v_pk_fma_f32 v[134:135], v[174:175], v[18:19], v[194:195] op_sel_hi:[1,0,1] neg_lo:[0,0,1] neg_hi:[0,0,1]
v_cvt_pk_bf16_f32 v132, v132, v133
v_cvt_pk_bf16_f32 v133, v134, v135
ds_write_b64 v29, v[132:133] offset:96
v_pk_fma_f32 v[136:137], v[176:177], v[18:19], v[196:197] op_sel_hi:[1,0,1] neg_lo:[0,0,1] neg_hi:[0,0,1]
v_pk_fma_f32 v[138:139], v[178:179], v[18:19], v[198:199] op_sel_hi:[1,0,1] neg_lo:[0,0,1] neg_hi:[0,0,1]
v_cvt_pk_bf16_f32 v136, v136, v137
v_cvt_pk_bf16_f32 v137, v138, v139
ds_write_b64 v29, v[136:137] offset:128
ds_read_b128 v[140:143], v30
ds_read_b128 v[144:147], v31
ds_read_b128 v[148:151], v32
s_cbranch_vccnz L_2_un
L_2_ok:
s_waitcnt lgkmcnt(2)
buffer_store_dwordx4 v[140:143], v33, s[92:95], s45 offen
s_waitcnt lgkmcnt(1)
buffer_store_dwordx4 v[144:147], v34, s[92:95], s45 offen
s_mov_b32 exec_hi, 0
s_waitcnt lgkmcnt(0)
buffer_store_dwordx4 v[148:151], v35, s[92:95], s45 offen
s_endpgm
L_2_h0:
s_cmp_eq_u32 s52, 0
s_cbranch_scc1 L_2_r0
s_sub_u32 s52, s52, 1
buffer_load_dword v16, v3, s[12:15], s46 offen sc1
s_add_u32 s58, s51, 0
buffer_load_dwordx4 v[40:43], v2, s[12:15], s58 offen offset:0 sc1
buffer_load_dwordx4 v[44:47], v2, s[12:15], s58 offen offset:1024 sc1
buffer_load_dwordx4 v[48:51], v2, s[12:15], s58 offen offset:2048 sc1
buffer_load_dwordx4 v[52:55], v2, s[12:15], s58 offen offset:3072 sc1
s_add_u32 s58, s51, 4096
buffer_load_dwordx4 v[56:59], v2, s[12:15], s58 offen offset:0 sc1
buffer_load_dwordx4 v[60:63], v2, s[12:15], s58 offen offset:1024 sc1
buffer_load_dwordx4 v[64:67], v2, s[12:15], s58 offen offset:2048 sc1
buffer_load_dwordx4 v[68:71], v2, s[12:15], s58 offen offset:3072 sc1
s_waitcnt vmcnt(6)
v_max3_u32 v5, v16, v40, v44
v_cmp_eq_u32 vcc, 4290772927, v5
s_cbranch_vccnz L_2_h0
s_branch L_2_r0
L_2_h1:
s_cmp_eq_u32 s52, 0
s_cbranch_scc1 L_2_r1
s_sub_u32 s52, s52, 1
s_add_u32 s58, s51, 0
buffer_load_dwordx4 v[48:51], v2, s[12:15], s58 offen offset:2048 sc1
buffer_load_dwordx4 v[52:55], v2, s[12:15], s58 offen offset:3072 sc1
s_add_u32 s58, s51, 4096
buffer_load_dwordx4 v[56:59], v2, s[12:15], s58 offen offset:0 sc1
buffer_load_dwordx4 v[60:63], v2, s[12:15], s58 offen offset:1024 sc1
buffer_load_dwordx4 v[64:67], v2, s[12:15], s58 offen offset:2048 sc1
buffer_load_dwordx4 v[68:71], v2, s[12:15], s58 offen offset:3072 sc1
s_add_u32 s58, s51, 8192
buffer_load_dwordx4 v[72:75], v2, s[12:15], s58 offen offset:0 sc1
buffer_load_dwordx4 v[76:79], v2, s[12:15], s58 offen offset:1024 sc1
s_waitcnt vmcnt(6)
v_max3_u32 v5, v55, v48, v52
v_cmp_eq_u32 vcc, 4290772927, v5
s_cbranch_vccnz L_2_h1
s_branch L_2_r1
L_2_h2:
s_cmp_eq_u32 s52, 0
s_cbranch_scc1 L_2_r2
s_sub_u32 s52, s52, 1
s_add_u32 s58, s51, 4096
buffer_load_dwordx4 v[56:59], v2, s[12:15], s58 offen offset:0 sc1
buffer_load_dwordx4 v[60:63], v2, s[12:15], s58 offen offset:1024 sc1
buffer_load_dwordx4 v[64:67], v2, s[12:15], s58 offen offset:2048 sc1
buffer_load_dwordx4 v[68:71], v2, s[12:15], s58 offen offset:3072 sc1
s_add_u32 s58, s51, 8192
buffer_load_dwordx4 v[72:75], v2, s[12:15], s58 offen offset:0 sc1
buffer_load_dwordx4 v[76:79], v2, s[12:15], s58 offen offset:1024 sc1
buffer_load_dwordx4 v[80:83], v2, s[12:15], s58 offen offset:2048 sc1
buffer_load_dwordx4 v[84:87], v2, s[12:15], s58 offen offset:3072 sc1
s_waitcnt vmcnt(6)
v_max3_u32 v5, v63, v56, v60
v_cmp_eq_u32 vcc, 4290772927, v5
s_cbranch_vccnz L_2_h2
s_branch L_2_r2
L_2_h3:
s_cmp_eq_u32 s52, 0
s_cbranch_scc1 L_2_r3
s_sub_u32 s52, s52, 1
s_add_u32 s58, s51, 4096
buffer_load_dwordx4 v[64:67], v2, s[12:15], s58 offen offset:2048 sc1
buffer_load_dwordx4 v[68:71], v2, s[12:15], s58 offen offset:3072 sc1
s_add_u32 s58, s51, 8192
buffer_load_dwordx4 v[72:75], v2, s[12:15], s58 offen offset:0 sc1
buffer_load_dwordx4 v[76:79], v2, s[12:15], s58 offen offset:1024 sc1
buffer_load_dwordx4 v[80:83], v2, s[12:15], s58 offen offset:2048 sc1
buffer_load_dwordx4 v[84:87], v2, s[12:15], s58 offen offset:3072 sc1
s_add_u32 s58, s51, 12288
buffer_load_dwordx4 v[88:91], v2, s[12:15], s58 offen offset:0 sc1
buffer_load_dwordx4 v[92:95], v2, s[12:15], s58 offen offset:1024 sc1
s_waitcnt vmcnt(6)
v_max3_u32 v5, v71, v64, v68
v_cmp_eq_u32 vcc, 4290772927, v5
s_cbranch_vccnz L_2_h3
s_branch L_2_r3
L_2_h4:
s_cmp_eq_u32 s52, 0
s_cbranch_scc1 L_2_r4
s_sub_u32 s52, s52, 1
s_add_u32 s58, s51, 8192
buffer_load_dwordx4 v[72:75], v2, s[12:15], s58 offen offset:0 sc1
buffer_load_dwordx4 v[76:79], v2, s[12:15], s58 offen offset:1024 sc1
buffer_load_dwordx4 v[80:83], v2, s[12:15], s58 offen offset:2048 sc1
buffer_load_dwordx4 v[84:87], v2, s[12:15], s58 offen offset:3072 sc1
s_add_u32 s58, s51, 12288
buffer_load_dwordx4 v[88:91], v2, s[12:15], s58 offen offset:0 sc1
buffer_load_dwordx4 v[92:95], v2, s[12:15], s58 offen offset:1024 sc1
buffer_load_dwordx4 v[96:99], v2, s[12:15], s58 offen offset:2048 sc1
buffer_load_dwordx4 v[100:103], v2, s[12:15], s58 offen offset:3072 sc1
s_waitcnt vmcnt(6)
v_max3_u32 v5, v79, v72, v76
v_cmp_eq_u32 vcc, 4290772927, v5
s_cbranch_vccnz L_2_h4
s_branch L_2_r4
L_2_h5:
s_cmp_eq_u32 s52, 0
s_cbranch_scc1 L_2_r5
s_sub_u32 s52, s52, 1
s_add_u32 s58, s51, 8192
buffer_load_dwordx4 v[80:83], v2, s[12:15], s58 offen offset:2048 sc1
buffer_load_dwordx4 v[84:87], v2, s[12:15], s58 offen offset:3072 sc1
s_add_u32 s58, s51, 12288
buffer_load_dwordx4 v[88:91], v2, s[12:15], s58 offen offset:0 sc1
buffer_load_dwordx4 v[92:95], v2, s[12:15], s58 offen offset:1024 sc1
buffer_load_dwordx4 v[96:99], v2, s[12:15], s58 offen offset:2048 sc1
buffer_load_dwordx4 v[100:103], v2, s[12:15], s58 offen offset:3072 sc1
s_add_u32 s58, s51, 16384
buffer_load_dwordx4 v[104:107], v2, s[12:15], s58 offen offset:0 sc1
buffer_load_dwordx4 v[108:111], v2, s[12:15], s58 offen offset:1024 sc1
s_waitcnt vmcnt(6)
v_max3_u32 v5, v87, v80, v84
v_cmp_eq_u32 vcc, 4290772927, v5
s_cbranch_vccnz L_2_h5
s_branch L_2_r5
L_2_h6:
s_cmp_eq_u32 s52, 0
s_cbranch_scc1 L_2_r6
s_sub_u32 s52, s52, 1
s_add_u32 s58, s51, 12288
buffer_load_dwordx4 v[88:91], v2, s[12:15], s58 offen offset:0 sc1
buffer_load_dwordx4 v[92:95], v2, s[12:15], s58 offen offset:1024 sc1
buffer_load_dwordx4 v[96:99], v2, s[12:15], s58 offen offset:2048 sc1
buffer_load_dwordx4 v[100:103], v2, s[12:15], s58 offen offset:3072 sc1
s_add_u32 s58, s51, 16384
buffer_load_dwordx4 v[104:107], v2, s[12:15], s58 offen offset:0 sc1
buffer_load_dwordx4 v[108:111], v2, s[12:15], s58 offen offset:1024 sc1
buffer_load_dwordx4 v[112:115], v2, s[12:15], s58 offen offset:2048 sc1
buffer_load_dwordx4 v[116:119], v2, s[12:15], s58 offen offset:3072 sc1
s_waitcnt vmcnt(6)
v_max3_u32 v5, v95, v88, v92
v_cmp_eq_u32 vcc, 4290772927, v5
s_cbranch_vccnz L_2_h6
s_branch L_2_r6
L_2_h7:
s_cmp_eq_u32 s52, 0
s_cbranch_scc1 L_2_r7
s_sub_u32 s52, s52, 1
s_add_u32 s58, s51, 12288
buffer_load_dwordx4 v[96:99], v2, s[12:15], s58 offen offset:2048 sc1
buffer_load_dwordx4 v[100:103], v2, s[12:15], s58 offen offset:3072 sc1
s_add_u32 s58, s51, 16384
buffer_load_dwordx4 v[104:107], v2, s[12:15], s58 offen offset:0 sc1
buffer_load_dwordx4 v[108:111], v2, s[12:15], s58 offen offset:1024 sc1
buffer_load_dwordx4 v[112:115], v2, s[12:15], s58 offen offset:2048 sc1
buffer_load_dwordx4 v[116:119], v2, s[12:15], s58 offen offset:3072 sc1
s_waitcnt vmcnt(4)
v_max3_u32 v5, v103, v96, v100
v_cmp_eq_u32 vcc, 4290772927, v5
s_cbranch_vccnz L_2_h7
s_branch L_2_r7
L_2_h8:
s_cmp_eq_u32 s52, 0
s_cbranch_scc1 L_2_r8
s_sub_u32 s52, s52, 1
s_add_u32 s58, s51, 16384
buffer_load_dwordx4 v[104:107], v2, s[12:15], s58 offen offset:0 sc1
buffer_load_dwordx4 v[108:111], v2, s[12:15], s58 offen offset:1024 sc1
buffer_load_dwordx4 v[112:115], v2, s[12:15], s58 offen offset:2048 sc1
buffer_load_dwordx4 v[116:119], v2, s[12:15], s58 offen offset:3072 sc1
s_waitcnt vmcnt(2)
v_max3_u32 v5, v111, v104, v108
v_cmp_eq_u32 vcc, 4290772927, v5
s_cbranch_vccnz L_2_h8
s_branch L_2_r8
L_2_h9:
s_cmp_eq_u32 s52, 0
s_cbranch_scc1 L_2_r9
s_sub_u32 s52, s52, 1
s_add_u32 s58, s51, 16384
buffer_load_dwordx4 v[112:115], v2, s[12:15], s58 offen offset:2048 sc1
buffer_load_dwordx4 v[116:119], v2, s[12:15], s58 offen offset:3072 sc1
s_waitcnt vmcnt(0)
v_max3_u32 v5, v119, v112, v116
v_cmp_eq_u32 vcc, 4290772927, v5
s_cbranch_vccnz L_2_h9
s_branch L_2_r9
L_2_lw:
v_mov_b32 v10, 112832
s_mov_b32 s59, 131072
L_lw13:
ds_read_b128 v[6:9], v10
s_sub_u32 s59, s59, 1
s_cbranch_scc1 L_lx13
s_waitcnt lgkmcnt(0)
v_min3_u32 v6, v6, v7, v8
v_min_u32 v6, v6, v9
v_cmp_eq_u32 vcc, 0, v6
s_cbranch_vccz L_lx13
s_sleep 1
s_branch L_lw13
L_lx13:
s_branch L_2_lr
L_2_un:
v_xor_b32 v5, 4290772927, v16
v_xor_b32 v6, 4290772927, v40
v_xor_b32 v7, 4290772927, v41
v_min3_u32 v5, v5, v6, v7
v_xor_b32 v6, 4290772927, v42
v_xor_b32 v7, 4290772927, v43
v_min3_u32 v5, v5, v6, v7
v_xor_b32 v6, 4290772927, v44
v_xor_b32 v7, 4290772927, v45
v_min3_u32 v5, v5, v6, v7
v_xor_b32 v6, 4290772927, v46
v_xor_b32 v7, 4290772927, v47
v_min3_u32 v5, v5, v6, v7
v_xor_b32 v6, 4290772927, v48
v_xor_b32 v7, 4290772927, v49
v_min3_u32 v5, v5, v6, v7
v_xor_b32 v6, 4290772927, v50
v_xor_b32 v7, 4290772927, v51
v_min3_u32 v5, v5, v6, v7
v_xor_b32 v6, 4290772927, v52
v_xor_b32 v7, 4290772927, v53
v_min3_u32 v5, v5, v6, v7
v_xor_b32 v6, 4290772927, v54
v_xor_b32 v7, 4290772927, v55
v_min3_u32 v5, v5, v6, v7
v_xor_b32 v6, 4290772927, v56
v_xor_b32 v7, 4290772927, v57
v_min3_u32 v5, v5, v6, v7
v_xor_b32 v6, 4290772927, v58
v_xor_b32 v7, 4290772927, v59
v_min3_u32 v5, v5, v6, v7
v_xor_b32 v6, 4290772927, v60
v_xor_b32 v7, 4290772927, v61
v_min3_u32 v5, v5, v6, v7
v_xor_b32 v6, 4290772927, v62
v_xor_b32 v7, 4290772927, v63
v_min3_u32 v5, v5, v6, v7
v_xor_b32 v6, 4290772927, v64
v_xor_b32 v7, 4290772927, v65
v_min3_u32 v5, v5, v6, v7
v_xor_b32 v6, 4290772927, v66
v_xor_b32 v7, 4290772927, v67
v_min3_u32 v5, v5, v6, v7
v_xor_b32 v6, 4290772927, v68
v_xor_b32 v7, 4290772927, v69
v_min3_u32 v5, v5, v6, v7
v_xor_b32 v6, 4290772927, v70
v_xor_b32 v7, 4290772927, v71
v_min3_u32 v5, v5, v6, v7
v_xor_b32 v6, 4290772927, v72
v_xor_b32 v7, 4290772927, v73
v_min3_u32 v5, v5, v6, v7
v_xor_b32 v6, 4290772927, v74
v_xor_b32 v7, 4290772927, v75
v_min3_u32 v5, v5, v6, v7
v_xor_b32 v6, 4290772927, v76
v_xor_b32 v7, 4290772927, v77
v_min3_u32 v5, v5, v6, v7
v_xor_b32 v6, 4290772927, v78
v_xor_b32 v7, 4290772927, v79
v_min3_u32 v5, v5, v6, v7
v_xor_b32 v6, 4290772927, v80
v_xor_b32 v7, 4290772927, v81
v_min3_u32 v5, v5, v6, v7
v_xor_b32 v6, 4290772927, v82
v_xor_b32 v7, 4290772927, v83
v_min3_u32 v5, v5, v6, v7
v_xor_b32 v6, 4290772927, v84
v_xor_b32 v7, 4290772927, v85
v_min3_u32 v5, v5, v6, v7
v_xor_b32 v6, 4290772927, v86
v_xor_b32 v7, 4290772927, v87
v_min3_u32 v5, v5, v6, v7
v_xor_b32 v6, 4290772927, v88
v_xor_b32 v7, 4290772927, v89
v_min3_u32 v5, v5, v6, v7
v_xor_b32 v6, 4290772927, v90
v_xor_b32 v7, 4290772927, v91
v_min3_u32 v5, v5, v6, v7
v_xor_b32 v6, 4290772927, v92
v_xor_b32 v7, 4290772927, v93
v_min3_u32 v5, v5, v6, v7
v_xor_b32 v6, 4290772927, v94
v_xor_b32 v7, 4290772927, v95
v_min3_u32 v5, v5, v6, v7
v_xor_b32 v6, 4290772927, v96
v_xor_b32 v7, 4290772927, v97
v_min3_u32 v5, v5, v6, v7
v_xor_b32 v6, 4290772927, v98
v_xor_b32 v7, 4290772927, v99
v_min3_u32 v5, v5, v6, v7
v_xor_b32 v6, 4290772927, v100
v_xor_b32 v7, 4290772927, v101
v_min3_u32 v5, v5, v6, v7
v_xor_b32 v6, 4290772927, v102
v_xor_b32 v7, 4290772927, v103
v_min3_u32 v5, v5, v6, v7
v_xor_b32 v6, 4290772927, v104
v_xor_b32 v7, 4290772927, v105
v_min3_u32 v5, v5, v6, v7
v_xor_b32 v6, 4290772927, v106
v_xor_b32 v7, 4290772927, v107
v_min3_u32 v5, v5, v6, v7
v_xor_b32 v6, 4290772927, v108
v_xor_b32 v7, 4290772927, v109
v_min3_u32 v5, v5, v6, v7
v_xor_b32 v6, 4290772927, v110
v_xor_b32 v7, 4290772927, v111
v_min3_u32 v5, v5, v6, v7
v_xor_b32 v6, 4290772927, v112
v_xor_b32 v7, 4290772927, v113
v_min3_u32 v5, v5, v6, v7
v_xor_b32 v6, 4290772927, v114
v_xor_b32 v7, 4290772927, v115
v_min3_u32 v5, v5, v6, v7
v_xor_b32 v6, 4290772927, v116
v_xor_b32 v7, 4290772927, v117
v_min3_u32 v5, v5, v6, v7
v_xor_b32 v6, 4290772927, v118
v_xor_b32 v7, 4290772927, v119
v_min3_u32 v5, v5, v6, v7
v_cmp_eq_u32 vcc, 0, v5
s_cbranch_vccz L_2_ok
s_cmp_eq_u32 s52, 0
s_cbranch_scc1 L_2_ok
s_sub_u32 s52, s52, 1
s_mov_b32 s44, s51
s_branch L_2_st
L_2_b0:
s_mov_b32 s59, 262144
L_bw14:
s_cmp_eq_u32 s53, 1
s_cbranch_scc1 L_bt15
ds_read_b32 v25, v24
s_waitcnt lgkmcnt(0)
v_cmp_eq_u32 vcc, 0, v25
s_cbranch_vccnz L_bt15
s_call_b64 s[56:57], L_2_bp
L_bt15:
s_cmp_eq_u32 s53, 1
s_cbranch_scc1 L_bx14
s_sleep 2
s_sub_u32 s59, s59, 1
s_cbranch_scc0 L_bw14
s_call_b64 s[56:57], L_2_bp
L_bx14:
s_nop 7
s_branch L_2_b9
L_code_end:
.fill (0xb880-(L_code_end-gated_mix__sliding_local_dilated__spectral_fnet__prompt_kernel))/4, 4, 0xbf810000
.section .rodata,"a"
.p2align 6
.amdhsa_kernel gated_mix__sliding_local_dilated__spectral_fnet__prompt_kernel
  .amdhsa_next_free_vgpr 256
  .amdhsa_next_free_sgpr 100
  .amdhsa_accum_offset 256
  .amdhsa_group_segment_fixed_size 0
  .amdhsa_kernarg_size 96
  .amdhsa_user_sgpr_count 2
  .amdhsa_user_sgpr_kernarg_segment_ptr 1
  .amdhsa_system_sgpr_workgroup_id_x 1
  .amdhsa_float_denorm_mode_32 3
.end_amdhsa_kernel
```
